```python
import torch

def _softmax(x, axis=-1):
    return torch.softmax(x, dim=axis)
def _gelu(x):
    return torch.nn.functional.gelu(x, approximate="tanh")
def _silu(x):
    return torch.nn.functional.silu(x)
def _sigmoid(x):
    return torch.sigmoid(x)
def _layernorm(x, axis=-1, eps=1e-5):
    m = x.mean(dim=axis, keepdim=True)
    v = x.var(dim=axis, keepdim=True, unbiased=False)
    return (x - m) / torch.sqrt(v + eps)
def _scatter_add(tgt, idx, src, axis=0):
    return tgt.clone().index_add_(axis, idx, src)
def _segment_sum(src, seg, n):
    out = torch.zeros((n,) + src.shape[1:], dtype=src.dtype)
    return out.index_add_(0, seg, src)
def _pad(x, pw):
    flat = tuple(v for pair in reversed(pw) for v in pair)
    return torch.nn.functional.pad(x, flat)

kernel_name = 'gated_mix__sliding_block_cached__glu_gated_bilinear__decode'

def setup_inputs():

    _w = (lambda a: (lambda t: t.to(torch.bfloat16) if t.is_floating_point() else t)(torch.as_tensor(a)))
    def _A_setup():
        B, Sq, D = 2, 1, 512
        Hq, Hkv, Sk, Dh = 32, 32, 4096, 128
        assert Hq % Hkv == 0, (Hq, Hkv)
        return {
            "x": _w((lambda *s: torch.randn(*s, dtype=torch.bfloat16) * 0.05)(B, Sq, D)),
            "k_cache": _w((lambda *s: torch.randn(*s, dtype=torch.bfloat16) * 6.4)(B, Hkv, Sk, Dh)),
            "v_cache": _w((lambda *s: torch.randn(*s, dtype=torch.bfloat16) * 0.05)(B, Hkv, Sk, Dh)),
            "wq": _w((lambda *s: torch.randn(*s, dtype=torch.bfloat16) * 6.4)(D, Hq * Dh) * (D ** -0.5)),
            "wo": _w((lambda *s: torch.randn(*s, dtype=torch.bfloat16) * 0.05)(Hq * Dh, D) * ((Hq * Dh) ** -0.5)),
        }
    _A_in = _A_setup()

    def _B_setup():
        B, S, D, F = 2, 1, 512, 1376
        return {
            "x": _w((lambda *s: torch.randn(*s, dtype=torch.bfloat16) * 0.05)(B, S, D)),
            "w_gate": _w((lambda *s: torch.randn(*s, dtype=torch.bfloat16) * 0.4)(D, F) * (D ** -0.5)),
            "w_up": _w((lambda *s: torch.randn(*s, dtype=torch.bfloat16) * 0.4)(D, F) * (D ** -0.5)),
            "w_down": _w((lambda *s: torch.randn(*s, dtype=torch.bfloat16) * 0.4)(F, D) * (F ** -0.5)),
        }
    _B_in = _B_setup()

    return {
        "A_x": _A_in["x"],
        "A_k_cache": _A_in["k_cache"],
        "A_v_cache": _A_in["v_cache"],
        "A_wq": _A_in["wq"],
        "A_wo": _A_in["wo"],
        "B_x": _B_in["x"],
        "B_w_gate": _B_in["w_gate"],
        "B_w_up": _B_in["w_up"],
        "B_w_down": _B_in["w_down"],
        "gate_w": _w((lambda *s: torch.randn(*s, dtype=torch.bfloat16) * 0.05)(512) * 16.0),
    }

def reference(A_x, A_k_cache, A_v_cache, A_wq, A_wo, B_x, B_w_gate, B_w_up, B_w_down, gate_w):
    def _A_ref(x, k_cache, v_cache, wq, wo):
        B, Sq, D = x.shape
        Hq, Dh = 32, 128
        Hkv, Sk = k_cache.shape[1], k_cache.shape[2]
        W = min(4096, max(256, Sk // 4))
        rep = Hq // Hkv
        q = (lambda x, *d: x.permute(*d))((x @ wq).reshape(B, Sq, Hq, Dh), 0, 2, 1, 3)
        k = (lambda x, n, axis: torch.repeat_interleave(x, n, dim=axis))(k_cache[:, :, Sk - W:, :], rep, axis=1)
        v = (lambda x, n, axis: torch.repeat_interleave(x, n, dim=axis))(v_cache[:, :, Sk - W:, :], rep, axis=1)
        scores = torch.einsum("bhqd,bhkd->bhqk", q, k) * (Dh ** -0.5)
        p = _softmax(scores, axis=-1)
        o = torch.einsum("bhqk,bhkd->bhqd", p, v)
        return (lambda x, *d: x.permute(*d))(o, 0, 2, 1, 3).reshape(B, Sq, Hq * Dh) @ wo

    def _B_ref(x, w_gate, w_up, w_down):
        g = torch.einsum("bsd,df->bsf", x, w_gate)
        u = torch.einsum("bsd,df->bsf", x, w_up)
        h = g * u
        return torch.einsum("bsf,fd->bsd", h, w_down)

    x = A_x
    g = _sigmoid((x * gate_w).sum(-1, keepdims=True))
    a = _A_ref(x, A_k_cache, A_v_cache, A_wq, A_wo)
    b = _B_ref(x, B_w_gate, B_w_up, B_w_down)
    return g * a + (1 - g) * b
```

```asm
; @launch grid=(256,1,1) block=(384,1,1) lds=2560
.amdgcn_target "amdgcn-amd-amdhsa--gfx950"
.text
.globl gated_mix__sliding_block_cached__glu_gated_bilinear__decode_kernel
.p2align 8
.type gated_mix__sliding_block_cached__glu_gated_bilinear__decode_kernel,@function
gated_mix__sliding_block_cached__glu_gated_bilinear__decode_kernel:
    s_cmp_ge_u32 s2, 256
    s_cbranch_scc1 L_exit
    s_load_dwordx8 s[32:39], s[0:1], 0
    s_load_dwordx8 s[40:47], s[0:1], 32
    s_load_dwordx8 s[48:55], s[0:1], 64
    s_load_dwordx2 s[56:57], s[0:1], 96
    v_lshrrev_b32 v1, 6, v0
    v_and_b32 v0, 63, v0
    s_lshr_b32 s4, s2, 3
    v_readfirstlane_b32 s3, v1
    s_and_b32 s5, s2, 7
    v_lshrrev_b32 v2, 4, v0
    v_and_b32 v3, 15, v0
    v_mov_b32 v4, 0
    s_mov_b64 s[58:59], -1
    s_cmp_eq_u32 s3, 5
    s_cbranch_scc1 L_B
    s_cmp_lg_u32 s3, 0
    s_cbranch_scc1 L_S
    s_setprio 3
    v_mov_b32 v5, 0
    v_mov_b32 v6, 0
    v_mov_b32 v7, 0
    ds_write_b128 v4, v[4:7] offset:0
    ds_write_b32 v4, v4 offset:16
    v_lshrrev_b32 v8, 3, v3
    v_lshlrev_b32 v8, 10, v8
    v_lshl_add_u32 v24, v2, 5, v8
    v_lshlrev_b32 v9, 17, v2
    v_lshl_add_u32 v1, v3, 4, v9
    s_lshl_b32 s12, s5, 7
    s_lshl_b32 s13, s5, 19
    s_lshl_b32 s15, s4, 8
    s_add_u32 s13, s13, s15
    s_movk_i32 s16, 0x2000
    s_mov_b32 s62, 4194304
    s_mov_b32 s63, 0x20000
    s_mov_b32 s66, 2048
    s_mov_b32 s67, 0x20000
    s_waitcnt lgkmcnt(0)
    s_mov_b64 s[60:61], s[38:39]
    s_mov_b64 s[64:65], s[32:33]
    buffer_load_dwordx4 v[8:11], v24, s[64:67], s12 offen
    buffer_load_dwordx4 v[12:15], v24, s[64:67], s12 offen offset:16
    buffer_load_dwordx4 v[32:35], v1, s[60:63], s13 offen nt
    s_add_u32 s13, s13, s16
    buffer_load_dwordx4 v[36:39], v1, s[60:63], s13 offen nt
    s_add_u32 s13, s13, s16
    buffer_load_dwordx4 v[40:43], v1, s[60:63], s13 offen nt
    s_add_u32 s13, s13, s16
    buffer_load_dwordx4 v[44:47], v1, s[60:63], s13 offen nt
    s_add_u32 s13, s13, s16
    buffer_load_dwordx4 v[48:51], v1, s[60:63], s13 offen nt
    s_add_u32 s13, s13, s16
    buffer_load_dwordx4 v[52:55], v1, s[60:63], s13 offen nt
    s_add_u32 s13, s13, s16
    buffer_load_dwordx4 v[56:59], v1, s[60:63], s13 offen nt
    s_add_u32 s13, s13, s16
    buffer_load_dwordx4 v[60:63], v1, s[60:63], s13 offen nt
    s_add_u32 s13, s13, s16
    buffer_load_dwordx4 v[64:67], v1, s[60:63], s13 offen nt
    s_add_u32 s13, s13, s16
    buffer_load_dwordx4 v[68:71], v1, s[60:63], s13 offen nt
    s_add_u32 s13, s13, s16
    buffer_load_dwordx4 v[72:75], v1, s[60:63], s13 offen nt
    s_add_u32 s13, s13, s16
    buffer_load_dwordx4 v[76:79], v1, s[60:63], s13 offen nt
    s_add_u32 s13, s13, s16
    buffer_load_dwordx4 v[80:83], v1, s[60:63], s13 offen nt
    s_add_u32 s13, s13, s16
    buffer_load_dwordx4 v[84:87], v1, s[60:63], s13 offen nt
    s_add_u32 s13, s13, s16
    buffer_load_dwordx4 v[88:91], v1, s[60:63], s13 offen nt
    s_add_u32 s13, s13, s16
    buffer_load_dwordx4 v[92:95], v1, s[60:63], s13 offen nt
    s_load_dword s6, s[56:57], 0
    s_barrier
    s_mov_b64 s[68:69], s[56:57]
    s_mov_b32 s70, 2097152
    s_mov_b32 s71, 0x20000
    v_and_b32 v24, 1, v0
    v_cmp_eq_u32 vcc, 1, v24
    v_mov_b32 v25, 0x0c0c0100
    v_mov_b32 v26, 0x01000c0c
    v_mov_b32 v27, 0x0c0c0302
    v_mov_b32 v28, 0x03020c0c
    v_cndmask_b32 v25, v25, v26, vcc
    v_cndmask_b32 v27, v27, v28, vcc
    v_bfe_u32 v24, v0, 1, 2
    v_mov_b32 v26, 0x0c0c0c0c
    v_cmp_eq_u32 vcc, 0, v24
    s_nop 1
    v_cndmask_b32 v16, v26, v25, vcc
    v_cndmask_b32 v17, v26, v27, vcc
    v_cmp_eq_u32 vcc, 1, v24
    s_nop 1
    v_cndmask_b32 v18, v26, v25, vcc
    v_cndmask_b32 v19, v26, v27, vcc
    v_cmp_eq_u32 vcc, 2, v24
    s_nop 1
    v_cndmask_b32 v20, v26, v25, vcc
    v_cndmask_b32 v21, v26, v27, vcc
    v_cmp_eq_u32 vcc, 3, v24
    s_nop 1
    v_cndmask_b32 v22, v26, v25, vcc
    v_cndmask_b32 v23, v26, v27, vcc
    v_lshlrev_b32 v5, 4, v0
    s_lshl_b32 s15, s2, 10
    s_add_u32 s15, s15, 4096
    v_and_b32 v160, 7, v3
    s_cmp_eq_u32 s4, 21
    s_cselect_b32 s14, 3, 7
    v_and_b32 v160, s14, v160
    v_lshlrev_b32 v160, 4, v160
    s_mov_b32 s14, 44032
    v_mad_u32_u24 v160, v2, s14, v160
    s_mul_i32 s14, s5, 176128
    s_lshl_b32 s16, s4, 7
    s_add_u32 s14, s14, s16
    v_add_u32 v160, s14, v160
    v_mov_b32 v161, 0
    v_cmp_gt_u32 vcc, 8, v3
    v_mov_b32 v158, s46
    v_mov_b32 v159, s47
    v_mov_b32 v162, s44
    v_mov_b32 v163, s45
    v_cndmask_b32 v158, v158, v162, vcc
    v_cndmask_b32 v159, v159, v163, vcc
    v_lshl_add_u64 v[158:159], v[160:161], 0, v[158:159]
    s_mov_b32 s16, 5504
    s_mov_b32 s17, 0
    s_cmp_lt_u32 s4, 22
    s_cselect_b64 vcc, -1, 0
    v_mov_b32 v160, 1
    s_waitcnt lgkmcnt(0)
    v_mov_b32 v161, s6
    ds_write_b64 v4, v[160:161] offset:16
    s_mul_i32 s7, s6, 0x9E3779B1
    s_add_u32 s7, s7, 0x7F4A7C15
    s_lshr_b32 s8, s7, 15
    s_xor_b32 s7, s7, s8
    s_mul_i32 s7, s7, 0x85EBCA6B
    s_lshr_b32 s8, s7, 13
    s_xor_b32 s7, s7, s8
    v_mov_b32 v164, s7
    v_lshrrev_b32 v165, 8, v164
    v_lshrrev_b32 v166, 16, v164
    v_lshrrev_b32 v167, 24, v164
    v_mov_b32 v6, 0xff
    s_waitcnt vmcnt(16) lgkmcnt(0)
    v_perm_b32 v24, v8, v8, v16
    v_perm_b32 v25, v8, v8, v18
    v_perm_b32 v26, v8, v8, v20
    v_perm_b32 v27, v8, v8, v22
    v_perm_b32 v28, v8, v8, v17
    v_perm_b32 v29, v8, v8, v19
    v_perm_b32 v30, v8, v8, v21
    v_perm_b32 v31, v8, v8, v23
    s_waitcnt vmcnt(15)
    v_mfma_f32_16x16x32_bf16 v[160:163], v[24:27], v[32:35], 0
    v_perm_b32 v24, v9, v9, v16
    v_perm_b32 v25, v9, v9, v18
    v_perm_b32 v26, v9, v9, v20
    v_perm_b32 v27, v9, v9, v22
    s_waitcnt vmcnt(14)
    v_mfma_f32_16x16x32_bf16 v[160:163], v[28:31], v[36:39], v[160:163]
    v_perm_b32 v28, v9, v9, v17
    v_perm_b32 v29, v9, v9, v19
    v_perm_b32 v30, v9, v9, v21
    v_perm_b32 v31, v9, v9, v23
    s_waitcnt vmcnt(13)
    v_mfma_f32_16x16x32_bf16 v[160:163], v[24:27], v[40:43], v[160:163]
    v_perm_b32 v24, v10, v10, v16
    v_perm_b32 v25, v10, v10, v18
    v_perm_b32 v26, v10, v10, v20
    v_perm_b32 v27, v10, v10, v22
    s_waitcnt vmcnt(12)
    v_mfma_f32_16x16x32_bf16 v[160:163], v[28:31], v[44:47], v[160:163]
    v_perm_b32 v28, v10, v10, v17
    v_perm_b32 v29, v10, v10, v19
    v_perm_b32 v30, v10, v10, v21
    v_perm_b32 v31, v10, v10, v23
    s_waitcnt vmcnt(11)
    v_mfma_f32_16x16x32_bf16 v[160:163], v[24:27], v[48:51], v[160:163]
    v_perm_b32 v24, v11, v11, v16
    v_perm_b32 v25, v11, v11, v18
    v_perm_b32 v26, v11, v11, v20
    v_perm_b32 v27, v11, v11, v22
    s_waitcnt vmcnt(10)
    v_mfma_f32_16x16x32_bf16 v[160:163], v[28:31], v[52:55], v[160:163]
    v_perm_b32 v28, v11, v11, v17
    v_perm_b32 v29, v11, v11, v19
    v_perm_b32 v30, v11, v11, v21
    v_perm_b32 v31, v11, v11, v23
    s_waitcnt vmcnt(9)
    v_mfma_f32_16x16x32_bf16 v[160:163], v[24:27], v[56:59], v[160:163]
    v_perm_b32 v24, v12, v12, v16
    v_perm_b32 v25, v12, v12, v18
    v_perm_b32 v26, v12, v12, v20
    v_perm_b32 v27, v12, v12, v22
    s_waitcnt vmcnt(8)
    v_mfma_f32_16x16x32_bf16 v[160:163], v[28:31], v[60:63], v[160:163]
    v_perm_b32 v28, v12, v12, v17
    v_perm_b32 v29, v12, v12, v19
    v_perm_b32 v30, v12, v12, v21
    v_perm_b32 v31, v12, v12, v23
    s_waitcnt vmcnt(7)
    v_mfma_f32_16x16x32_bf16 v[160:163], v[24:27], v[64:67], v[160:163]
    v_perm_b32 v24, v13, v13, v16
    v_perm_b32 v25, v13, v13, v18
    v_perm_b32 v26, v13, v13, v20
    v_perm_b32 v27, v13, v13, v22
    s_waitcnt vmcnt(6)
    v_mfma_f32_16x16x32_bf16 v[160:163], v[28:31], v[68:71], v[160:163]
    v_perm_b32 v28, v13, v13, v17
    v_perm_b32 v29, v13, v13, v19
    v_perm_b32 v30, v13, v13, v21
    v_perm_b32 v31, v13, v13, v23
    s_waitcnt vmcnt(5)
    v_mfma_f32_16x16x32_bf16 v[160:163], v[24:27], v[72:75], v[160:163]
    v_perm_b32 v24, v14, v14, v16
    v_perm_b32 v25, v14, v14, v18
    v_perm_b32 v26, v14, v14, v20
    v_perm_b32 v27, v14, v14, v22
    s_waitcnt vmcnt(4)
    v_mfma_f32_16x16x32_bf16 v[160:163], v[28:31], v[76:79], v[160:163]
    v_perm_b32 v28, v14, v14, v17
    v_perm_b32 v29, v14, v14, v19
    v_perm_b32 v30, v14, v14, v21
    v_perm_b32 v31, v14, v14, v23
    s_waitcnt vmcnt(3)
    v_mfma_f32_16x16x32_bf16 v[160:163], v[24:27], v[80:83], v[160:163]
    v_perm_b32 v24, v15, v15, v16
    v_perm_b32 v25, v15, v15, v18
    v_perm_b32 v26, v15, v15, v20
    v_perm_b32 v27, v15, v15, v22
    s_waitcnt vmcnt(2)
    v_mfma_f32_16x16x32_bf16 v[160:163], v[28:31], v[84:87], v[160:163]
    v_perm_b32 v28, v15, v15, v17
    v_perm_b32 v29, v15, v15, v19
    v_perm_b32 v30, v15, v15, v21
    v_perm_b32 v31, v15, v15, v23
    s_waitcnt vmcnt(1)
    v_mfma_f32_16x16x32_bf16 v[160:163], v[24:27], v[88:91], v[160:163]
    s_waitcnt vmcnt(0)
    v_mfma_f32_16x16x32_bf16 v[160:163], v[28:31], v[92:95], v[160:163]
    v_mov_b32 v94, 0x0c0c0400
    v_mov_b32 v95, 0x04000c0c
    s_lshl_b32 s14, s4, 13
    s_lshr_b32 s18, s5, 2
    s_lshl_b32 s18, s18, 9
    s_add_u32 s14, s14, s18
    s_add_u32 s14, s14, 4096
    s_add_u32 s18, s56, s14
    v_bfi_b32 v160, v6, v164, v160
    v_bfi_b32 v161, v6, v165, v161
    v_bfi_b32 v162, v6, v166, v162
    v_bfi_b32 v163, v6, v167, v163
    buffer_store_dwordx4 v[160:163], v5, s[68:71], s15 offen sc1
    s_addc_u32 s19, s57, 0
    s_cbranch_vccz L_A_nogu1
    global_load_dwordx4 v[96:99], v[158:159], off nt
    global_load_dwordx4 v[100:103], v[158:159], off offset:2752 nt
    v_lshl_add_u64 v[158:159], v[158:159], 0, s[16:17]
    global_load_dwordx4 v[104:107], v[158:159], off nt
    global_load_dwordx4 v[108:111], v[158:159], off offset:2752 nt
    v_lshl_add_u64 v[158:159], v[158:159], 0, s[16:17]
    global_load_dwordx4 v[112:115], v[158:159], off nt
    global_load_dwordx4 v[116:119], v[158:159], off offset:2752 nt
    v_lshl_add_u64 v[158:159], v[158:159], 0, s[16:17]
    global_load_dwordx4 v[120:123], v[158:159], off nt
    global_load_dwordx4 v[124:127], v[158:159], off offset:2752 nt
    v_lshl_add_u64 v[158:159], v[158:159], 0, s[16:17]
    global_load_dwordx4 v[128:131], v[158:159], off nt
    global_load_dwordx4 v[132:135], v[158:159], off offset:2752 nt
    v_lshl_add_u64 v[158:159], v[158:159], 0, s[16:17]
    global_load_dwordx4 v[136:139], v[158:159], off nt
    global_load_dwordx4 v[140:143], v[158:159], off offset:2752 nt
    v_lshl_add_u64 v[158:159], v[158:159], 0, s[16:17]
    global_load_dwordx4 v[144:147], v[158:159], off nt
    global_load_dwordx4 v[148:151], v[158:159], off offset:2752 nt
    v_lshl_add_u64 v[158:159], v[158:159], 0, s[16:17]
    global_load_dwordx4 v[152:155], v[158:159], off nt
    global_load_dwordx4 v[156:159], v[158:159], off offset:2752 nt
L_A_nogu1:
    s_lshr_b32 s9, s7, 24
    s_mov_b32 s11, 40000
    v_lshrrev_b32 v39, 5, v0
    v_and_b32 v37, 31, v0
    v_lshlrev_b32 v36, 4, v37
    v_lshl_add_u32 v36, v39, 10, v36
    s_add_u32 s16, s14, 4096
    v_lshlrev_b32 v37, 4, v3
    v_and_b32 v38, 1, v2
    v_lshl_add_u32 v37, v38, 3, v37
    v_lshl_add_u32 v37, v39, 1, v37
    v_and_b32 v38, 1, v0
    v_lshlrev_b32 v38, 7, v38
    v_bfe_u32 v39, v0, 2, 1
    v_lshl_add_u32 v38, v39, 6, v38
    v_bfe_u32 v39, v0, 1, 1
    v_lshl_add_u32 v38, v39, 5, v38
    v_lshrrev_b32 v39, 3, v0
    v_lshl_add_u32 v38, v39, 2, v38
    v_mov_b32 v39, 1
    s_lshl_b32 s15, s2, 10
    s_add_u32 s15, s15, 524288
    s_lshl_b32 s20, s5, 10
    s_add_u32 s20, s20, 508
L_A_s0:
    s_load_dword s21, s[18:19], s20 glc
    s_sub_u32 s11, s11, 1
    s_cbranch_scc1 L_A_spd
    s_waitcnt lgkmcnt(0)
    s_xor_b32 s21, s21, s9
    s_and_b32 s21, s21, 0xff
    s_cbranch_scc1 L_A_s0
L_A_sp:
    s_load_dword s20, s[18:19], 508 glc
    s_load_dword s21, s[18:19], 1532 glc
    s_load_dword s22, s[18:19], 2556 glc
    s_load_dword s23, s[18:19], 3580 glc
    s_load_dword s24, s[18:19], 4604 glc
    s_load_dword s25, s[18:19], 5628 glc
    s_load_dword s26, s[18:19], 6652 glc
    s_load_dword s27, s[18:19], 7676 glc
    s_sub_u32 s11, s11, 1
    s_cbranch_scc1 L_A_spd
    s_waitcnt lgkmcnt(0)
    s_xor_b32 s20, s20, s9
    s_xor_b32 s21, s21, s9
    s_xor_b32 s22, s22, s9
    s_xor_b32 s23, s23, s9
    s_xor_b32 s24, s24, s9
    s_xor_b32 s25, s25, s9
    s_xor_b32 s26, s26, s9
    s_xor_b32 s27, s27, s9
    s_or_b32 s20, s20, s21
    s_or_b32 s20, s20, s22
    s_or_b32 s20, s20, s23
    s_or_b32 s20, s20, s24
    s_or_b32 s20, s20, s25
    s_or_b32 s20, s20, s26
    s_or_b32 s20, s20, s27
    s_and_b32 s20, s20, 0xff
    s_cbranch_scc1 L_A_sp
L_A_spd:
    buffer_load_dwordx4 v[40:43], v36, s[68:71], s14 offen offset:0 sc1
    buffer_load_dwordx4 v[44:47], v36, s[68:71], s14 offen offset:2048 sc1
    buffer_load_dwordx4 v[48:51], v36, s[68:71], s16 offen offset:0 sc1
    buffer_load_dwordx4 v[52:55], v36, s[68:71], s16 offen offset:2048 sc1
    s_cbranch_vccz L_A_q
    v_perm_b32 v24, v8, v8, v16
    v_perm_b32 v25, v8, v8, v18
    v_perm_b32 v26, v8, v8, v20
    v_perm_b32 v27, v8, v8, v22
    v_perm_b32 v28, v8, v8, v17
    v_perm_b32 v29, v8, v8, v19
    v_perm_b32 v30, v8, v8, v21
    v_perm_b32 v31, v8, v8, v23
    s_waitcnt vmcnt(19)
    v_mfma_f32_16x16x32_bf16 v[32:35], v[24:27], v[96:99], 0
    v_perm_b32 v24, v9, v9, v16
    v_perm_b32 v25, v9, v9, v18
    v_perm_b32 v26, v9, v9, v20
    v_perm_b32 v27, v9, v9, v22
    s_waitcnt vmcnt(18)
    v_mfma_f32_16x16x32_bf16 v[32:35], v[28:31], v[100:103], v[32:35]
    v_perm_b32 v28, v9, v9, v17
    v_perm_b32 v29, v9, v9, v19
    v_perm_b32 v30, v9, v9, v21
    v_perm_b32 v31, v9, v9, v23
    s_waitcnt vmcnt(17)
    v_mfma_f32_16x16x32_bf16 v[32:35], v[24:27], v[104:107], v[32:35]
    v_perm_b32 v24, v10, v10, v16
    v_perm_b32 v25, v10, v10, v18
    v_perm_b32 v26, v10, v10, v20
    v_perm_b32 v27, v10, v10, v22
    s_waitcnt vmcnt(16)
    v_mfma_f32_16x16x32_bf16 v[32:35], v[28:31], v[108:111], v[32:35]
    v_perm_b32 v28, v10, v10, v17
    v_perm_b32 v29, v10, v10, v19
    v_perm_b32 v30, v10, v10, v21
    v_perm_b32 v31, v10, v10, v23
    s_waitcnt vmcnt(15)
    v_mfma_f32_16x16x32_bf16 v[32:35], v[24:27], v[112:115], v[32:35]
    v_perm_b32 v24, v11, v11, v16
    v_perm_b32 v25, v11, v11, v18
    v_perm_b32 v26, v11, v11, v20
    v_perm_b32 v27, v11, v11, v22
    s_waitcnt vmcnt(14)
    v_mfma_f32_16x16x32_bf16 v[32:35], v[28:31], v[116:119], v[32:35]
    v_perm_b32 v28, v11, v11, v17
    v_perm_b32 v29, v11, v11, v19
    v_perm_b32 v30, v11, v11, v21
    v_perm_b32 v31, v11, v11, v23
    s_waitcnt vmcnt(13)
    v_mfma_f32_16x16x32_bf16 v[32:35], v[24:27], v[120:123], v[32:35]
    v_perm_b32 v24, v12, v12, v16
    v_perm_b32 v25, v12, v12, v18
    v_perm_b32 v26, v12, v12, v20
    v_perm_b32 v27, v12, v12, v22
    s_waitcnt vmcnt(12)
    v_mfma_f32_16x16x32_bf16 v[32:35], v[28:31], v[124:127], v[32:35]
    v_perm_b32 v28, v12, v12, v17
    v_perm_b32 v29, v12, v12, v19
    v_perm_b32 v30, v12, v12, v21
    v_perm_b32 v31, v12, v12, v23
    s_waitcnt vmcnt(11)
    v_mfma_f32_16x16x32_bf16 v[32:35], v[24:27], v[128:131], v[32:35]
    v_perm_b32 v24, v13, v13, v16
    v_perm_b32 v25, v13, v13, v18
    v_perm_b32 v26, v13, v13, v20
    v_perm_b32 v27, v13, v13, v22
    s_waitcnt vmcnt(10)
    v_mfma_f32_16x16x32_bf16 v[32:35], v[28:31], v[132:135], v[32:35]
    v_perm_b32 v28, v13, v13, v17
    v_perm_b32 v29, v13, v13, v19
    v_perm_b32 v30, v13, v13, v21
    v_perm_b32 v31, v13, v13, v23
    s_waitcnt vmcnt(9)
    v_mfma_f32_16x16x32_bf16 v[32:35], v[24:27], v[136:139], v[32:35]
    v_perm_b32 v24, v14, v14, v16
    v_perm_b32 v25, v14, v14, v18
    v_perm_b32 v26, v14, v14, v20
    v_perm_b32 v27, v14, v14, v22
    s_waitcnt vmcnt(8)
    v_mfma_f32_16x16x32_bf16 v[32:35], v[28:31], v[140:143], v[32:35]
    v_perm_b32 v28, v14, v14, v17
    v_perm_b32 v29, v14, v14, v19
    v_perm_b32 v30, v14, v14, v21
    v_perm_b32 v31, v14, v14, v23
    s_waitcnt vmcnt(7)
    v_mfma_f32_16x16x32_bf16 v[32:35], v[24:27], v[144:147], v[32:35]
    v_perm_b32 v24, v15, v15, v16
    v_perm_b32 v25, v15, v15, v18
    v_perm_b32 v26, v15, v15, v20
    v_perm_b32 v27, v15, v15, v22
    s_waitcnt vmcnt(6)
    v_mfma_f32_16x16x32_bf16 v[32:35], v[28:31], v[148:151], v[32:35]
    v_perm_b32 v28, v15, v15, v17
    v_perm_b32 v29, v15, v15, v19
    v_perm_b32 v30, v15, v15, v21
    v_perm_b32 v31, v15, v15, v23
    s_waitcnt vmcnt(5)
    v_mfma_f32_16x16x32_bf16 v[32:35], v[24:27], v[152:155], v[32:35]
    s_waitcnt vmcnt(4)
    v_mfma_f32_16x16x32_bf16 v[32:35], v[28:31], v[156:159], v[32:35]
L_A_q:
    s_waitcnt vmcnt(0)
    s_mov_b64 s[28:29], vcc
    s_mov_b32 s11, 40000
Lgc_2:
    v_perm_b32 v56, v41, v40, v94
    v_perm_b32 v57, v43, v42, v95
    v_perm_b32 v58, v45, v44, v94
    v_perm_b32 v59, v47, v46, v95
    v_perm_b32 v60, v49, v48, v94
    v_perm_b32 v61, v51, v50, v95
    v_perm_b32 v62, v53, v52, v94
    v_perm_b32 v63, v55, v54, v95
    v_or_b32 v56, v56, v57
    v_xor_b32 v56, s7, v56
    v_or_b32 v58, v58, v59
    v_xor_b32 v58, s7, v58
    v_or_b32 v60, v60, v61
    v_xor_b32 v60, s7, v60
    v_or_b32 v62, v62, v63
    v_xor_b32 v62, s7, v62
    v_or_b32 v56, v56, v58
    v_or_b32 v56, v56, v60
    v_or_b32 v56, v56, v62
    v_cmp_ne_u32 vcc, 0, v56
    s_and_b64 exec, exec, vcc
    s_cbranch_scc1 Lg_1
Lg_1d:
    s_mov_b64 exec, s[58:59]
    v_and_b32 v40, 0xffffff00, v40
    v_and_b32 v41, 0xffffff00, v41
    v_and_b32 v42, 0xffffff00, v42
    v_and_b32 v43, 0xffffff00, v43
    v_and_b32 v44, 0xffffff00, v44
    v_and_b32 v45, 0xffffff00, v45
    v_and_b32 v46, 0xffffff00, v46
    v_and_b32 v47, 0xffffff00, v47
    v_and_b32 v48, 0xffffff00, v48
    v_and_b32 v49, 0xffffff00, v49
    v_and_b32 v50, 0xffffff00, v50
    v_and_b32 v51, 0xffffff00, v51
    v_and_b32 v52, 0xffffff00, v52
    v_and_b32 v53, 0xffffff00, v53
    v_and_b32 v54, 0xffffff00, v54
    v_and_b32 v55, 0xffffff00, v55
    v_add_f32 v40, v40, v44
    v_add_f32 v41, v41, v45
    v_add_f32 v42, v42, v46
    v_add_f32 v43, v43, v47
    v_add_f32 v40, v40, v48
    v_add_f32 v41, v41, v49
    v_add_f32 v42, v42, v50
    v_add_f32 v43, v43, v51
    v_add_f32 v40, v40, v52
    v_add_f32 v41, v41, v53
    v_add_f32 v42, v42, v54
    v_add_f32 v43, v43, v55
    s_nop 0
    v_permlane32_swap_b32 v40, v41
    v_permlane32_swap_b32 v42, v43
    s_nop 1
    v_add_f32 v40, v40, v41
    v_add_f32 v42, v42, v43
    v_cvt_pk_bf16_f32 v40, v40, v42
    s_waitcnt lgkmcnt(0)
    ds_write_b16 v37, v40 offset:64
    ds_write_b16_d16_hi v37, v40 offset:68
    ds_write_b32 v4, v39 offset:0
    s_cmp_eq_u64 s[28:29], 0
    s_cbranch_scc1 L_A_nogu3
    ds_bpermute_b32 v40, v38, v32
    ds_bpermute_b32 v41, v38, v33
    ds_bpermute_b32 v42, v38, v34
    ds_bpermute_b32 v43, v38, v35
    s_waitcnt lgkmcnt(0)
    v_bfi_b32 v40, v6, v164, v40
    v_bfi_b32 v41, v6, v165, v41
    v_bfi_b32 v42, v6, v166, v42
    v_bfi_b32 v43, v6, v167, v43
    buffer_store_dwordx4 v[40:43], v5, s[68:71], s15 offen sc1
L_A_nogu3:
    s_mov_b32 s11, 400000
Lp_3:
    ds_read_b32 v36, v4 offset:8
    s_sub_u32 s11, s11, 1
    s_cbranch_scc1 Lpd_4
    s_waitcnt lgkmcnt(0)
    v_readfirstlane_b32 s10, v36
    s_cmp_lt_u32 s10, 4
    s_cbranch_scc1 Lp_3
Lpd_4:
    ds_read_b128 v[44:47], v4 offset:448
    ds_read_b128 v[56:59], v4 offset:464
    s_mov_b32 s16, 1069066811
    v_lshlrev_b32 v38, 4, v0
    s_lshl_b32 s15, s2, 10
    s_add_u32 s15, s15, 786432
    s_waitcnt lgkmcnt(0)
    v_max3_f32 v48, v44, v46, v56
    v_max_f32 v48, v48, v58
    v_sub_f32 v52, v44, v48
    v_sub_f32 v53, v46, v48
    v_sub_f32 v54, v56, v48
    v_sub_f32 v55, v58, v48
    v_mul_f32 v52, s16, v52
    v_mul_f32 v53, s16, v53
    v_mul_f32 v54, s16, v54
    v_mul_f32 v55, s16, v55
    v_exp_f32 v52, v52
    v_exp_f32 v53, v53
    v_exp_f32 v54, v54
    v_exp_f32 v55, v55
    s_nop 0
    v_mul_f32 v49, v52, v45
    v_fma_f32 v49, v53, v47, v49
    v_fma_f32 v49, v54, v57, v49
    v_fma_f32 v49, v55, v59, v49
    v_mov_b32 v50, 0
    v_mov_b32 v51, 0
    v_bfi_b32 v48, v6, v164, v48
    v_bfi_b32 v49, v6, v165, v49
    v_bfi_b32 v50, v6, v166, v50
    v_bfi_b32 v51, v6, v167, v51
    s_mov_b64 exec, 1
    buffer_store_dwordx4 v[48:51], v4, s[68:71], s15 offen offset:512 sc1
    s_mov_b32 exec_lo, -1
    s_mov_b32 s11, 400000
Lp_5:
    ds_read_b32 v36, v4 offset:12
    ds_read_b128 v[60:63], v38 offset:512
    ds_read_b128 v[64:67], v38 offset:1024
    ds_read_b128 v[68:71], v38 offset:1536
    ds_read_b128 v[72:75], v38 offset:2048
    s_sub_u32 s11, s11, 1
    s_cbranch_scc1 Lpd_6
    s_waitcnt lgkmcnt(4)
    v_readfirstlane_b32 s10, v36
    s_cmp_lt_u32 s10, 4
    s_cbranch_scc1 Lp_5
Lpd_6:
L_A_comb:
    s_waitcnt lgkmcnt(3)
    v_mul_f32 v60, v52, v60
    v_mul_f32 v61, v52, v61
    v_mul_f32 v62, v52, v62
    v_mul_f32 v63, v52, v63
    s_waitcnt lgkmcnt(2)
    v_fma_f32 v60, v53, v64, v60
    v_fma_f32 v61, v53, v65, v61
    v_fma_f32 v62, v53, v66, v62
    v_fma_f32 v63, v53, v67, v63
    s_waitcnt lgkmcnt(1)
    v_fma_f32 v60, v54, v68, v60
    v_fma_f32 v61, v54, v69, v61
    v_fma_f32 v62, v54, v70, v62
    v_fma_f32 v63, v54, v71, v63
    s_waitcnt lgkmcnt(0)
    v_fma_f32 v60, v55, v72, v60
    v_fma_f32 v61, v55, v73, v61
    v_fma_f32 v62, v55, v74, v62
    v_fma_f32 v63, v55, v75, v63
    v_bfi_b32 v60, v6, v164, v60
    v_bfi_b32 v61, v6, v165, v61
    v_bfi_b32 v62, v6, v166, v62
    v_bfi_b32 v63, v6, v167, v63
    s_cbranch_execz L_B_h
    buffer_store_dwordx4 v[60:63], v38, s[68:71], s15 offen sc1
    s_endpgm
L_S:
    s_lshr_b32 s12, s5, 2
    s_lshl_b32 s12, s12, 5
    s_add_u32 s12, s12, s4
    s_lshl_b32 s12, s12, 4
    s_and_b32 s13, s5, 3
    s_add_u32 s12, s12, s13
    s_lshl_b32 s12, s12, 6
    s_add_u32 s12, s12, s3
    s_lshl_b32 s12, s12, 10
    s_add_u32 s12, s12, 785408
    s_sub_u32 s14, s3, 1
    v_lshlrev_b32 v1, 4, v0
    s_mov_b32 s62, 62464
    s_mov_b32 s63, 0x20000
    s_mov_b32 s66, 62464
    s_mov_b32 s67, 0x20000
    s_mov_b64 vcc, 0
    s_lshl_b32 s13, s2, 12
    s_and_b32 s13, s13, 0xffff
    s_waitcnt lgkmcnt(0)
    s_add_u32 s60, s34, s12
    s_addc_u32 s61, s35, 0
    s_add_u32 s64, s36, s12
    s_addc_u32 s65, s37, 0
    s_mov_b32 s38, s13
    s_barrier
    buffer_load_dwordx4 v[32:35], v1, s[60:63], s38 offen nt
    s_add_u32 s39, s38, 4096
    s_and_b32 s39, s39, 0xffff
    buffer_load_dwordx4 v[36:39], v1, s[60:63], s39 offen nt
    s_add_u32 s40, s39, 4096
    s_and_b32 s40, s40, 0xffff
    buffer_load_dwordx4 v[40:43], v1, s[60:63], s40 offen nt
    s_add_u32 s41, s40, 4096
    s_and_b32 s41, s41, 0xffff
    buffer_load_dwordx4 v[44:47], v1, s[60:63], s41 offen nt
    s_add_u32 s42, s41, 4096
    s_and_b32 s42, s42, 0xffff
    buffer_load_dwordx4 v[48:51], v1, s[60:63], s42 offen nt
    s_add_u32 s43, s42, 4096
    s_and_b32 s43, s43, 0xffff
    s_cbranch_vccnz Lw_7
    ds_read_b32 v5, v4 offset:0
    s_waitcnt vmcnt(4) lgkmcnt(0)
    v_cmp_ne_u32 vcc, 0, v5
Lw_7:
    buffer_load_dwordx4 v[52:55], v1, s[60:63], s43 offen nt
    s_add_u32 s44, s43, 4096
    s_and_b32 s44, s44, 0xffff
    s_cbranch_vccnz Lw_8
    ds_read_b32 v5, v4 offset:0
    s_waitcnt vmcnt(4) lgkmcnt(0)
    v_cmp_ne_u32 vcc, 0, v5
Lw_8:
    buffer_load_dwordx4 v[56:59], v1, s[60:63], s44 offen nt
    s_add_u32 s45, s44, 4096
    s_and_b32 s45, s45, 0xffff
    s_cbranch_vccnz Lw_9
    ds_read_b32 v5, v4 offset:0
    s_waitcnt vmcnt(4) lgkmcnt(0)
    v_cmp_ne_u32 vcc, 0, v5
Lw_9:
    buffer_load_dwordx4 v[60:63], v1, s[60:63], s45 offen nt
    s_add_u32 s46, s45, 4096
    s_and_b32 s46, s46, 0xffff
    s_cbranch_vccnz Lw_10
    ds_read_b32 v5, v4 offset:0
    s_waitcnt vmcnt(4) lgkmcnt(0)
    v_cmp_ne_u32 vcc, 0, v5
Lw_10:
    buffer_load_dwordx4 v[64:67], v1, s[60:63], s46 offen nt
    s_add_u32 s47, s46, 4096
    s_and_b32 s47, s47, 0xffff
    s_cbranch_vccnz Lw_11
    ds_read_b32 v5, v4 offset:0
    s_waitcnt vmcnt(4) lgkmcnt(0)
    v_cmp_ne_u32 vcc, 0, v5
Lw_11:
    buffer_load_dwordx4 v[68:71], v1, s[60:63], s47 offen nt
    s_add_u32 s48, s47, 4096
    s_and_b32 s48, s48, 0xffff
    s_cbranch_vccnz Lw_12
    ds_read_b32 v5, v4 offset:0
    s_waitcnt vmcnt(4) lgkmcnt(0)
    v_cmp_ne_u32 vcc, 0, v5
Lw_12:
    buffer_load_dwordx4 v[72:75], v1, s[60:63], s48 offen nt
    s_add_u32 s49, s48, 4096
    s_and_b32 s49, s49, 0xffff
    s_cbranch_vccnz Lw_13
    ds_read_b32 v5, v4 offset:0
    s_waitcnt vmcnt(4) lgkmcnt(0)
    v_cmp_ne_u32 vcc, 0, v5
Lw_13:
    buffer_load_dwordx4 v[76:79], v1, s[60:63], s49 offen nt
    s_add_u32 s50, s49, 4096
    s_and_b32 s50, s50, 0xffff
    s_cbranch_vccnz Lw_14
    ds_read_b32 v5, v4 offset:0
    s_waitcnt vmcnt(4) lgkmcnt(0)
    v_cmp_ne_u32 vcc, 0, v5
Lw_14:
    buffer_load_dwordx4 v[80:83], v1, s[60:63], s50 offen nt
    s_add_u32 s51, s50, 4096
    s_and_b32 s51, s51, 0xffff
    s_cbranch_vccnz Lw_15
    ds_read_b32 v5, v4 offset:0
    s_waitcnt vmcnt(4) lgkmcnt(0)
    v_cmp_ne_u32 vcc, 0, v5
Lw_15:
    buffer_load_dwordx4 v[84:87], v1, s[60:63], s51 offen nt
    s_add_u32 s52, s51, 4096
    s_and_b32 s52, s52, 0xffff
    s_cbranch_vccnz Lw_16
    ds_read_b32 v5, v4 offset:0
    s_waitcnt vmcnt(4) lgkmcnt(0)
    v_cmp_ne_u32 vcc, 0, v5
Lw_16:
    buffer_load_dwordx4 v[88:91], v1, s[60:63], s52 offen nt
    s_add_u32 s53, s52, 4096
    s_and_b32 s53, s53, 0xffff
    s_cbranch_vccnz Lw_17
    ds_read_b32 v5, v4 offset:0
    s_waitcnt vmcnt(4) lgkmcnt(0)
    v_cmp_ne_u32 vcc, 0, v5
Lw_17:
    buffer_load_dwordx4 v[92:95], v1, s[60:63], s53 offen nt
    s_cbranch_vccnz Lw_18
    ds_read_b32 v5, v4 offset:0
    s_waitcnt vmcnt(4) lgkmcnt(0)
    v_cmp_ne_u32 vcc, 0, v5
Lw_18:
    buffer_load_dwordx4 v[96:99], v1, s[64:67], s38 offen nt
    s_cbranch_vccnz Lw_19
    ds_read_b32 v5, v4 offset:0
    s_waitcnt vmcnt(4) lgkmcnt(0)
    v_cmp_ne_u32 vcc, 0, v5
Lw_19:
    buffer_load_dwordx4 v[100:103], v1, s[64:67], s39 offen nt
    s_cbranch_vccnz Lw_20
    ds_read_b32 v5, v4 offset:0
    s_waitcnt vmcnt(4) lgkmcnt(0)
    v_cmp_ne_u32 vcc, 0, v5
Lw_20:
    buffer_load_dwordx4 v[104:107], v1, s[64:67], s40 offen nt
    s_cbranch_vccnz Lw_21
    ds_read_b32 v5, v4 offset:0
    s_waitcnt vmcnt(4) lgkmcnt(0)
    v_cmp_ne_u32 vcc, 0, v5
Lw_21:
    buffer_load_dwordx4 v[108:111], v1, s[64:67], s41 offen nt
    s_cbranch_vccnz Lw_22
    ds_read_b32 v5, v4 offset:0
    s_waitcnt vmcnt(4) lgkmcnt(0)
    v_cmp_ne_u32 vcc, 0, v5
Lw_22:
    buffer_load_dwordx4 v[112:115], v1, s[64:67], s42 offen nt
    s_cbranch_vccnz Lw_23
    ds_read_b32 v5, v4 offset:0
    s_waitcnt vmcnt(4) lgkmcnt(0)
    v_cmp_ne_u32 vcc, 0, v5
Lw_23:
    buffer_load_dwordx4 v[116:119], v1, s[64:67], s43 offen nt
    s_cbranch_vccnz Lw_24
    ds_read_b32 v5, v4 offset:0
    s_waitcnt vmcnt(4) lgkmcnt(0)
    v_cmp_ne_u32 vcc, 0, v5
Lw_24:
    buffer_load_dwordx4 v[120:123], v1, s[64:67], s44 offen nt
    s_cbranch_vccnz Lw_25
    ds_read_b32 v5, v4 offset:0
    s_waitcnt vmcnt(4) lgkmcnt(0)
    v_cmp_ne_u32 vcc, 0, v5
Lw_25:
    buffer_load_dwordx4 v[124:127], v1, s[64:67], s45 offen nt
    s_cbranch_vccnz Lw_26
    ds_read_b32 v5, v4 offset:0
    s_waitcnt vmcnt(4) lgkmcnt(0)
    v_cmp_ne_u32 vcc, 0, v5
Lw_26:
    buffer_load_dwordx4 v[128:131], v1, s[64:67], s46 offen nt
    s_cbranch_vccnz Lw_27
    ds_read_b32 v5, v4 offset:0
    s_waitcnt vmcnt(4) lgkmcnt(0)
    v_cmp_ne_u32 vcc, 0, v5
Lw_27:
    buffer_load_dwordx4 v[132:135], v1, s[64:67], s47 offen nt
    buffer_load_dwordx4 v[136:139], v1, s[64:67], s48 offen nt
    buffer_load_dwordx4 v[140:143], v1, s[64:67], s49 offen nt
    buffer_load_dwordx4 v[144:147], v1, s[64:67], s50 offen nt
    buffer_load_dwordx4 v[148:151], v1, s[64:67], s51 offen nt
    buffer_load_dwordx4 v[152:155], v1, s[64:67], s52 offen nt
    buffer_load_dwordx4 v[156:159], v1, s[64:67], s53 offen nt
    v_and_b32 v5, 1, v0
    v_cmp_eq_u32 vcc, 1, v5
    v_mov_b32 v6, 0xffff
    v_mov_b32 v7, 0xffff0000
    v_cndmask_b32 v6, v6, v7, vcc
    v_lshrrev_b32 v5, 1, v3
    v_cmp_eq_u32 vcc, 0, v5
    s_nop 1
    v_cndmask_b32 v8, 0, v6, vcc
    v_cmp_eq_u32 vcc, 1, v5
    s_nop 1
    v_cndmask_b32 v9, 0, v6, vcc
    v_cmp_eq_u32 vcc, 2, v5
    s_nop 1
    v_cndmask_b32 v10, 0, v6, vcc
    v_cmp_eq_u32 vcc, 3, v5
    s_nop 1
    v_cndmask_b32 v11, 0, v6, vcc
    s_mov_b32 s11, 400000
Lp_28:
    ds_read_b32 v5, v4 offset:0
    s_sub_u32 s11, s11, 1
    s_cbranch_scc1 Lpd_29
    s_waitcnt lgkmcnt(0)
    v_readfirstlane_b32 s10, v5
    s_cmp_lt_u32 s10, 1
    s_cbranch_scc1 Lp_28
Lpd_29:
    s_waitcnt vmcnt(16)
L_S_qk:
    v_lshlrev_b32 v5, 4, v3
    ds_read_b128 v[28:31], v5 offset:64
    s_mov_b32 s15, 1035273459
    s_mov_b32 s16, 1069066811
    s_mov_b32 s17, 0xffff0000
    s_waitcnt lgkmcnt(0)
    v_dot2_f32_bf16 v12, v32, v28, 0
    v_dot2_f32_bf16 v13, v36, v28, 0
    v_dot2_f32_bf16 v14, v40, v28, 0
    v_dot2_f32_bf16 v15, v44, v28, 0
    v_dot2_f32_bf16 v16, v48, v28, 0
    v_dot2_f32_bf16 v17, v52, v28, 0
    v_dot2_f32_bf16 v18, v56, v28, 0
    v_dot2_f32_bf16 v19, v60, v28, 0
    v_dot2_f32_bf16 v20, v64, v28, 0
    v_dot2_f32_bf16 v21, v68, v28, 0
    v_dot2_f32_bf16 v22, v72, v28, 0
    v_dot2_f32_bf16 v23, v76, v28, 0
    v_dot2_f32_bf16 v24, v80, v28, 0
    v_dot2_f32_bf16 v25, v84, v28, 0
    v_dot2_f32_bf16 v26, v88, v28, 0
    v_dot2_f32_bf16 v27, v92, v28, 0
    v_dot2_f32_bf16 v12, v33, v29, v12
    v_dot2_f32_bf16 v13, v37, v29, v13
    v_dot2_f32_bf16 v14, v41, v29, v14
    v_dot2_f32_bf16 v15, v45, v29, v15
    v_dot2_f32_bf16 v16, v49, v29, v16
    v_dot2_f32_bf16 v17, v53, v29, v17
    v_dot2_f32_bf16 v18, v57, v29, v18
    v_dot2_f32_bf16 v19, v61, v29, v19
    v_dot2_f32_bf16 v20, v65, v29, v20
    v_dot2_f32_bf16 v21, v69, v29, v21
    v_dot2_f32_bf16 v22, v73, v29, v22
    v_dot2_f32_bf16 v23, v77, v29, v23
    v_dot2_f32_bf16 v24, v81, v29, v24
    v_dot2_f32_bf16 v25, v85, v29, v25
    v_dot2_f32_bf16 v26, v89, v29, v26
    v_dot2_f32_bf16 v27, v93, v29, v27
    v_dot2_f32_bf16 v12, v34, v30, v12
    v_dot2_f32_bf16 v13, v38, v30, v13
    v_dot2_f32_bf16 v14, v42, v30, v14
    v_dot2_f32_bf16 v15, v46, v30, v15
    v_dot2_f32_bf16 v16, v50, v30, v16
    v_dot2_f32_bf16 v17, v54, v30, v17
    v_dot2_f32_bf16 v18, v58, v30, v18
    v_dot2_f32_bf16 v19, v62, v30, v19
    v_dot2_f32_bf16 v20, v66, v30, v20
    v_dot2_f32_bf16 v21, v70, v30, v21
    v_dot2_f32_bf16 v22, v74, v30, v22
    v_dot2_f32_bf16 v23, v78, v30, v23
    v_dot2_f32_bf16 v24, v82, v30, v24
    v_dot2_f32_bf16 v25, v86, v30, v25
    v_dot2_f32_bf16 v26, v90, v30, v26
    v_dot2_f32_bf16 v27, v94, v30, v27
    v_dot2_f32_bf16 v12, v35, v31, v12
    v_dot2_f32_bf16 v13, v39, v31, v13
    v_dot2_f32_bf16 v14, v43, v31, v14
    v_dot2_f32_bf16 v15, v47, v31, v15
    v_dot2_f32_bf16 v16, v51, v31, v16
    v_dot2_f32_bf16 v17, v55, v31, v17
    v_dot2_f32_bf16 v18, v59, v31, v18
    v_dot2_f32_bf16 v19, v63, v31, v19
    v_dot2_f32_bf16 v20, v67, v31, v20
    v_dot2_f32_bf16 v21, v71, v31, v21
    v_dot2_f32_bf16 v22, v75, v31, v22
    v_dot2_f32_bf16 v23, v79, v31, v23
    v_dot2_f32_bf16 v24, v83, v31, v24
    v_dot2_f32_bf16 v25, v87, v31, v25
    v_dot2_f32_bf16 v26, v91, v31, v26
    v_dot2_f32_bf16 v27, v95, v31, v27
    v_add_f32_dpp v32, v12, v12 row_ror:8 row_mask:0xf bank_mask:0x3
    v_add_f32_dpp v33, v13, v13 row_ror:8 row_mask:0xf bank_mask:0x3
    v_add_f32_dpp v34, v14, v14 row_ror:8 row_mask:0xf bank_mask:0x3
    v_add_f32_dpp v35, v15, v15 row_ror:8 row_mask:0xf bank_mask:0x3
    v_add_f32_dpp v36, v16, v16 row_ror:8 row_mask:0xf bank_mask:0x3
    v_add_f32_dpp v37, v17, v17 row_ror:8 row_mask:0xf bank_mask:0x3
    v_add_f32_dpp v38, v18, v18 row_ror:8 row_mask:0xf bank_mask:0x3
    v_add_f32_dpp v39, v19, v19 row_ror:8 row_mask:0xf bank_mask:0x3
    v_add_f32_dpp v32, v20, v20 row_ror:8 row_mask:0xf bank_mask:0xc
    v_add_f32_dpp v33, v21, v21 row_ror:8 row_mask:0xf bank_mask:0xc
    v_add_f32_dpp v34, v22, v22 row_ror:8 row_mask:0xf bank_mask:0xc
    v_add_f32_dpp v35, v23, v23 row_ror:8 row_mask:0xf bank_mask:0xc
    v_add_f32_dpp v36, v24, v24 row_ror:8 row_mask:0xf bank_mask:0xc
    v_add_f32_dpp v37, v25, v25 row_ror:8 row_mask:0xf bank_mask:0xc
    v_add_f32_dpp v38, v26, v26 row_ror:8 row_mask:0xf bank_mask:0xc
    v_add_f32_dpp v39, v27, v27 row_ror:8 row_mask:0xf bank_mask:0xc
    v_add_f32_dpp v40, v32, v32 row_ror:12 row_mask:0xf bank_mask:0x5
    v_add_f32_dpp v41, v33, v33 row_ror:12 row_mask:0xf bank_mask:0x5
    v_add_f32_dpp v42, v34, v34 row_ror:12 row_mask:0xf bank_mask:0x5
    v_add_f32_dpp v43, v35, v35 row_ror:12 row_mask:0xf bank_mask:0x5
    v_add_f32_dpp v40, v36, v36 row_ror:4 row_mask:0xf bank_mask:0xa
    v_add_f32_dpp v41, v37, v37 row_ror:4 row_mask:0xf bank_mask:0xa
    v_add_f32_dpp v42, v38, v38 row_ror:4 row_mask:0xf bank_mask:0xa
    v_add_f32_dpp v43, v39, v39 row_ror:4 row_mask:0xf bank_mask:0xa
    v_and_b32 v5, 3, v0
    v_add_f32_dpp v40, v40, v40 quad_perm:[1,0,3,2] row_mask:0xf bank_mask:0xf
    v_add_f32_dpp v41, v41, v41 quad_perm:[1,0,3,2] row_mask:0xf bank_mask:0xf
    v_add_f32_dpp v42, v42, v42 quad_perm:[1,0,3,2] row_mask:0xf bank_mask:0xf
    v_add_f32_dpp v43, v43, v43 quad_perm:[1,0,3,2] row_mask:0xf bank_mask:0xf
    v_add_f32_dpp v40, v40, v40 quad_perm:[2,3,0,1] row_mask:0xf bank_mask:0xf
    v_add_f32_dpp v41, v41, v41 quad_perm:[2,3,0,1] row_mask:0xf bank_mask:0xf
    v_add_f32_dpp v42, v42, v42 quad_perm:[2,3,0,1] row_mask:0xf bank_mask:0xf
    v_add_f32_dpp v43, v43, v43 quad_perm:[2,3,0,1] row_mask:0xf bank_mask:0xf
    v_cmp_eq_u32 vcc, 1, v5
    v_cmp_eq_u32 s[20:21], 2, v5
    v_cmp_eq_u32 s[22:23], 3, v5
    s_nop 0
    v_cndmask_b32 v12, v40, v41, vcc
    v_cndmask_b32 v12, v12, v42, s[20:21]
    v_cndmask_b32 v12, v12, v43, s[22:23]
    v_cvt_pk_bf16_f32 v12, v12, v12
    v_and_b32 v12, s17, v12
    v_mul_f32 v12, s15, v12
    v_cvt_pk_bf16_f32 v12, v12, v12
    v_and_b32 v12, s17, v12
    s_nop 1
    v_max_f32_dpp v5, v12, v12 row_ror:8 row_mask:0xf bank_mask:0xf
    s_nop 1
    v_max_f32_dpp v5, v5, v5 row_ror:4 row_mask:0xf bank_mask:0xf
    s_nop 1
    v_max_f32_dpp v5, v5, v5 row_ror:2 row_mask:0xf bank_mask:0xf
    s_nop 1
    v_max_f32_dpp v5, v5, v5 row_ror:1 row_mask:0xf bank_mask:0xf
    v_mov_b32 v6, v5
    s_nop 1
    v_permlane32_swap_b32 v5, v6
    s_nop 1
    v_max_f32 v5, v5, v6
    v_mov_b32 v6, v5
    s_nop 1
    v_permlane16_swap_b32 v5, v6
    s_nop 1
    v_max_f32 v5, v5, v6
    v_sub_f32 v12, v12, v5
    v_mul_f32 v12, s16, v12
    v_exp_f32 v12, v12
    s_nop 0
    v_cvt_pk_bf16_f32 v13, v12, v12
    s_nop 0
    v_add_f32_dpp v7, v12, v12 row_ror:8 row_mask:0xf bank_mask:0xf
    v_and_b32_dpp v32, v13, v8 row_newbcast:0 row_mask:0xf bank_mask:0xf
    v_and_b32_dpp v33, v13, v9 row_newbcast:0 row_mask:0xf bank_mask:0xf
    v_and_b32_dpp v34, v13, v10 row_newbcast:0 row_mask:0xf bank_mask:0xf
    v_and_b32_dpp v35, v13, v11 row_newbcast:0 row_mask:0xf bank_mask:0xf
    v_add_f32_dpp v7, v7, v7 row_ror:4 row_mask:0xf bank_mask:0xf
    v_and_b32_dpp v36, v13, v8 row_newbcast:1 row_mask:0xf bank_mask:0xf
    v_and_b32_dpp v37, v13, v9 row_newbcast:1 row_mask:0xf bank_mask:0xf
    v_and_b32_dpp v38, v13, v10 row_newbcast:1 row_mask:0xf bank_mask:0xf
    v_and_b32_dpp v39, v13, v11 row_newbcast:1 row_mask:0xf bank_mask:0xf
    v_add_f32_dpp v7, v7, v7 row_ror:2 row_mask:0xf bank_mask:0xf
    v_and_b32_dpp v40, v13, v8 row_newbcast:2 row_mask:0xf bank_mask:0xf
    v_and_b32_dpp v41, v13, v9 row_newbcast:2 row_mask:0xf bank_mask:0xf
    v_and_b32_dpp v42, v13, v10 row_newbcast:2 row_mask:0xf bank_mask:0xf
    v_and_b32_dpp v43, v13, v11 row_newbcast:2 row_mask:0xf bank_mask:0xf
    v_add_f32_dpp v7, v7, v7 row_ror:1 row_mask:0xf bank_mask:0xf
    v_and_b32_dpp v44, v13, v8 row_newbcast:3 row_mask:0xf bank_mask:0xf
    v_and_b32_dpp v45, v13, v9 row_newbcast:3 row_mask:0xf bank_mask:0xf
    v_and_b32_dpp v46, v13, v10 row_newbcast:3 row_mask:0xf bank_mask:0xf
    v_and_b32_dpp v47, v13, v11 row_newbcast:3 row_mask:0xf bank_mask:0xf
    v_mov_b32 v6, v7
    v_and_b32_dpp v48, v13, v8 row_newbcast:4 row_mask:0xf bank_mask:0xf
    v_and_b32_dpp v49, v13, v9 row_newbcast:4 row_mask:0xf bank_mask:0xf
    v_and_b32_dpp v50, v13, v10 row_newbcast:4 row_mask:0xf bank_mask:0xf
    v_and_b32_dpp v51, v13, v11 row_newbcast:4 row_mask:0xf bank_mask:0xf
    v_permlane32_swap_b32 v6, v7
    v_and_b32_dpp v52, v13, v8 row_newbcast:5 row_mask:0xf bank_mask:0xf
    v_and_b32_dpp v53, v13, v9 row_newbcast:5 row_mask:0xf bank_mask:0xf
    v_and_b32_dpp v54, v13, v10 row_newbcast:5 row_mask:0xf bank_mask:0xf
    v_and_b32_dpp v55, v13, v11 row_newbcast:5 row_mask:0xf bank_mask:0xf
    v_add_f32 v7, v6, v7
    v_mov_b32 v6, v7
    v_and_b32_dpp v56, v13, v8 row_newbcast:6 row_mask:0xf bank_mask:0xf
    v_and_b32_dpp v57, v13, v9 row_newbcast:6 row_mask:0xf bank_mask:0xf
    v_and_b32_dpp v58, v13, v10 row_newbcast:6 row_mask:0xf bank_mask:0xf
    v_and_b32_dpp v59, v13, v11 row_newbcast:6 row_mask:0xf bank_mask:0xf
    v_permlane16_swap_b32 v6, v7
    v_and_b32_dpp v60, v13, v8 row_newbcast:7 row_mask:0xf bank_mask:0xf
    v_and_b32_dpp v61, v13, v9 row_newbcast:7 row_mask:0xf bank_mask:0xf
    v_and_b32_dpp v62, v13, v10 row_newbcast:7 row_mask:0xf bank_mask:0xf
    v_and_b32_dpp v63, v13, v11 row_newbcast:7 row_mask:0xf bank_mask:0xf
    v_add_f32 v7, v6, v7
    v_mov_b32 v6, v5
    s_lshl_b32 s13, s14, 3
    v_mov_b32 v14, s13
    v_mov_b32 v15, 1
    v_and_b32_dpp v64, v13, v8 row_newbcast:8 row_mask:0xf bank_mask:0xf
    v_and_b32_dpp v65, v13, v9 row_newbcast:8 row_mask:0xf bank_mask:0xf
    v_and_b32_dpp v66, v13, v10 row_newbcast:8 row_mask:0xf bank_mask:0xf
    v_and_b32_dpp v67, v13, v11 row_newbcast:8 row_mask:0xf bank_mask:0xf
    s_and_b64 exec, s[58:59], 1
    ds_write_b64 v14, v[6:7] offset:448
    ds_add_u32 v4, v15 offset:8
    s_mov_b64 exec, s[58:59]
    v_and_b32_dpp v68, v13, v8 row_newbcast:9 row_mask:0xf bank_mask:0xf
    v_and_b32_dpp v69, v13, v9 row_newbcast:9 row_mask:0xf bank_mask:0xf
    v_and_b32_dpp v70, v13, v10 row_newbcast:9 row_mask:0xf bank_mask:0xf
    v_and_b32_dpp v71, v13, v11 row_newbcast:9 row_mask:0xf bank_mask:0xf
    v_and_b32_dpp v72, v13, v8 row_newbcast:10 row_mask:0xf bank_mask:0xf
    v_and_b32_dpp v73, v13, v9 row_newbcast:10 row_mask:0xf bank_mask:0xf
    v_and_b32_dpp v74, v13, v10 row_newbcast:10 row_mask:0xf bank_mask:0xf
    v_and_b32_dpp v75, v13, v11 row_newbcast:10 row_mask:0xf bank_mask:0xf
    v_and_b32_dpp v76, v13, v8 row_newbcast:11 row_mask:0xf bank_mask:0xf
    v_and_b32_dpp v77, v13, v9 row_newbcast:11 row_mask:0xf bank_mask:0xf
    v_and_b32_dpp v78, v13, v10 row_newbcast:11 row_mask:0xf bank_mask:0xf
    v_and_b32_dpp v79, v13, v11 row_newbcast:11 row_mask:0xf bank_mask:0xf
    v_and_b32_dpp v80, v13, v8 row_newbcast:12 row_mask:0xf bank_mask:0xf
    v_and_b32_dpp v81, v13, v9 row_newbcast:12 row_mask:0xf bank_mask:0xf
    v_and_b32_dpp v82, v13, v10 row_newbcast:12 row_mask:0xf bank_mask:0xf
    v_and_b32_dpp v83, v13, v11 row_newbcast:12 row_mask:0xf bank_mask:0xf
    v_and_b32_dpp v84, v13, v8 row_newbcast:13 row_mask:0xf bank_mask:0xf
    v_and_b32_dpp v85, v13, v9 row_newbcast:13 row_mask:0xf bank_mask:0xf
    v_and_b32_dpp v86, v13, v10 row_newbcast:13 row_mask:0xf bank_mask:0xf
    v_and_b32_dpp v87, v13, v11 row_newbcast:13 row_mask:0xf bank_mask:0xf
    v_and_b32_dpp v88, v13, v8 row_newbcast:14 row_mask:0xf bank_mask:0xf
    v_and_b32_dpp v89, v13, v9 row_newbcast:14 row_mask:0xf bank_mask:0xf
    v_and_b32_dpp v90, v13, v10 row_newbcast:14 row_mask:0xf bank_mask:0xf
    v_and_b32_dpp v91, v13, v11 row_newbcast:14 row_mask:0xf bank_mask:0xf
    v_and_b32_dpp v92, v13, v8 row_newbcast:15 row_mask:0xf bank_mask:0xf
    v_and_b32_dpp v93, v13, v9 row_newbcast:15 row_mask:0xf bank_mask:0xf
    v_and_b32_dpp v94, v13, v10 row_newbcast:15 row_mask:0xf bank_mask:0xf
    v_and_b32_dpp v95, v13, v11 row_newbcast:15 row_mask:0xf bank_mask:0xf
    v_lshlrev_b32 v6, 5, v3
    v_lshl_add_u32 v6, v2, 4, v6
    s_lshl_b32 s13, s14, 9
    v_add_u32 v6, s13, v6
    s_waitcnt vmcnt(15)
    v_mfma_f32_16x16x32_bf16 v[160:163], v[32:35], v[96:99], 0
    s_waitcnt vmcnt(14)
    v_mfma_f32_16x16x32_bf16 v[160:163], v[36:39], v[100:103], v[160:163]
    s_waitcnt vmcnt(13)
    v_mfma_f32_16x16x32_bf16 v[160:163], v[40:43], v[104:107], v[160:163]
    s_waitcnt vmcnt(12)
    v_mfma_f32_16x16x32_bf16 v[160:163], v[44:47], v[108:111], v[160:163]
    s_waitcnt vmcnt(11)
    v_mfma_f32_16x16x32_bf16 v[160:163], v[48:51], v[112:115], v[160:163]
    s_waitcnt vmcnt(10)
    v_mfma_f32_16x16x32_bf16 v[160:163], v[52:55], v[116:119], v[160:163]
    s_waitcnt vmcnt(9)
    v_mfma_f32_16x16x32_bf16 v[160:163], v[56:59], v[120:123], v[160:163]
    s_waitcnt vmcnt(8)
    v_mfma_f32_16x16x32_bf16 v[160:163], v[60:63], v[124:127], v[160:163]
    s_waitcnt vmcnt(7)
    v_mfma_f32_16x16x32_bf16 v[160:163], v[64:67], v[128:131], v[160:163]
    s_and_b64 exec, s[58:59], 1
    ds_add_u32 v4, v15 offset:4
    s_mov_b64 exec, s[58:59]
    s_waitcnt vmcnt(6)
    v_mfma_f32_16x16x32_bf16 v[160:163], v[68:71], v[132:135], v[160:163]
    s_waitcnt vmcnt(5)
    v_mfma_f32_16x16x32_bf16 v[160:163], v[72:75], v[136:139], v[160:163]
    s_waitcnt vmcnt(4)
    v_mfma_f32_16x16x32_bf16 v[160:163], v[76:79], v[140:143], v[160:163]
    s_waitcnt vmcnt(3)
    v_mfma_f32_16x16x32_bf16 v[160:163], v[80:83], v[144:147], v[160:163]
    s_waitcnt vmcnt(2)
    v_mfma_f32_16x16x32_bf16 v[160:163], v[84:87], v[148:151], v[160:163]
    s_waitcnt vmcnt(1)
    v_mfma_f32_16x16x32_bf16 v[160:163], v[88:91], v[152:155], v[160:163]
    s_waitcnt vmcnt(0)
    v_mfma_f32_16x16x32_bf16 v[160:163], v[92:95], v[156:159], v[160:163]
    s_cbranch_execz L_B_dry4
    s_mov_b32 exec_hi, 0
    s_nop 5
    ds_write_b128 v6, v[160:163] offset:512
    s_mov_b64 exec, 1
    ds_add_u32 v4, v15 offset:12
    s_endpgm
L_B:
    v_lshlrev_b32 v1, 4, v0
    s_getpc_b64 s[20:21]
L_pc:
    s_sub_u32 s20, s20, L_pc-gated_mix__sliding_block_cached__glu_gated_bilinear__decode_kernel
    s_subb_u32 s21, s21, 0
    s_and_b32 s22, s4, 15
    s_lshl_b32 s22, s22, 10
    v_add_u32 v5, s22, v1
    v_min_u32 v5, L_exit-gated_mix__sliding_block_cached__glu_gated_bilinear__decode_kernel-16, v5
    v_and_b32 v5, 0xfffffff0, v5
    global_load_dwordx4 v[44:47], v5, s[20:21]
    s_barrier
    s_waitcnt lgkmcnt(0)
    s_lshr_b32 s13, s2, 2
    s_lshl_b32 s13, s13, 7
    s_add_u32 s13, s13, 1376256
    s_add_u32 s100, s56, s13
    s_addc_u32 s101, s57, 0
    s_load_dword s99, s[100:101], 0
    s_mov_b64 s[60:61], s[32:33]
    s_mov_b32 s62, 2048
    s_mov_b32 s63, 0x20000
    s_mov_b64 s[64:65], s[50:51]
    s_mov_b32 s66, 1024
    s_mov_b32 s67, 0x20000
    s_mov_b64 s[68:69], s[56:57]
    s_mov_b32 s70, 2097152
    s_mov_b32 s71, 0x20000
    s_mov_b64 s[72:73], s[52:53]
    s_mov_b32 s74, 2048
    s_mov_b32 s75, 0x20000
    buffer_load_dwordx4 v[56:59], v1, s[60:63], 0 offen
    buffer_load_dwordx4 v[60:63], v1, s[60:63], 0 offen offset:1024
    buffer_load_dwordx4 v[64:67], v1, s[64:67], 0 offen
    v_and_b32 v24, 1, v0
    v_cmp_eq_u32 vcc, 1, v24
    v_mov_b32 v25, 0x0c0c0100
    v_mov_b32 v26, 0x01000c0c
    v_mov_b32 v27, 0x0c0c0302
    v_mov_b32 v28, 0x03020c0c
    v_cndmask_b32 v25, v25, v26, vcc
    v_cndmask_b32 v27, v27, v28, vcc
    v_bfe_u32 v24, v0, 1, 2
    v_mov_b32 v26, 0x0c0c0c0c
    v_cmp_eq_u32 vcc, 0, v24
    s_nop 1
    v_cndmask_b32 v16, v26, v25, vcc
    v_cndmask_b32 v17, v26, v27, vcc
    v_cmp_eq_u32 vcc, 1, v24
    s_nop 1
    v_cndmask_b32 v18, v26, v25, vcc
    v_cndmask_b32 v19, v26, v27, vcc
    v_cmp_eq_u32 vcc, 2, v24
    s_nop 1
    v_cndmask_b32 v20, v26, v25, vcc
    v_cndmask_b32 v21, v26, v27, vcc
    v_cmp_eq_u32 vcc, 3, v24
    s_nop 1
    v_cndmask_b32 v22, v26, v25, vcc
    v_cndmask_b32 v23, v26, v27, vcc
    v_lshlrev_b32 v8, 10, v0
    v_and_b32 v14, 3, v0
    v_bfe_u32 v10, v0, 3, 1
    v_lshlrev_b32 v9, 2, v10
    v_bfe_u32 v10, v0, 2, 1
    v_add_u32 v9, v9, v10
    v_lshlrev_b32 v165, 2, v9
    v_lshlrev_b32 v9, 10, v9
    v_lshl_add_u32 v9, v2, 6, v9
    v_lshl_add_u32 v9, v14, 4, v9
    s_lshr_b32 s12, s5, 2
    s_lshl_b32 s19, s12, 8
    v_add_u32 v9, s19, v9
    v_bfe_u32 v10, v0, 3, 1
    v_lshlrev_b32 v10, 6, v10
    v_lshl_add_u32 v10, v2, 4, v10
    v_lshrrev_b32 v11, 2, v3
    v_lshl_add_u32 v11, v2, 2, v11
    v_lshlrev_b32 v11, 14, v11
    v_lshl_add_u32 v11, v14, 4, v11
    v_lshlrev_b32 v12, 4, v0
    v_and_b32 v13, 1, v2
    v_lshlrev_b32 v13, 2, v13
    v_lshl_add_u32 v13, v14, 4, v13
    v_lshrrev_b32 v14, 1, v2
    v_lshl_add_u32 v13, v14, 1, v13
    s_mov_b64 s[58:59], 0
    s_mov_b64 exec, 0
    s_branch L_A_comb
L_B_dry3:
    s_mov_b64 s[58:59], -1
    s_mov_b64 exec, -1
    s_mov_b32 s11, 400000
Lp_30:
    ds_read_b32 v7, v4 offset:16
    s_sub_u32 s11, s11, 1
    s_cbranch_scc1 Lpd_31
    s_waitcnt lgkmcnt(0)
    v_readfirstlane_b32 s10, v7
    s_cmp_lt_u32 s10, 1
    s_cbranch_scc1 Lp_30
Lpd_31:
    ds_read_b32 v7, v4 offset:20
    s_mov_b32 s17, 0xffff0000
    s_waitcnt lgkmcnt(0)
    v_readfirstlane_b32 s6, v7
    s_mul_i32 s7, s6, 0x9E3779B1
    s_add_u32 s7, s7, 0x7F4A7C15
    s_lshr_b32 s8, s7, 15
    s_xor_b32 s7, s7, s8
    s_mul_i32 s7, s7, 0x85EBCA6B
    s_lshr_b32 s8, s7, 13
    s_xor_b32 s7, s7, s8
    v_mov_b32 v144, s7
    v_lshrrev_b32 v145, 8, v144
    v_lshrrev_b32 v146, 16, v144
    v_lshrrev_b32 v147, 24, v144
    v_mov_b32 v148, 0xff
    v_mov_b32 v149, 0x0c0c0400
    v_mov_b32 v150, 0x04000c0c
    s_waitcnt vmcnt(0)
    v_lshlrev_b32 v68, 16, v64
    v_and_b32 v69, s17, v64
    v_lshlrev_b32 v70, 16, v65
    v_and_b32 v71, s17, v65
    v_lshlrev_b32 v72, 16, v66
    v_and_b32 v73, s17, v66
    v_lshlrev_b32 v74, 16, v67
    v_and_b32 v75, s17, v67
    v_lshlrev_b32 v76, 16, v56
    v_and_b32 v77, s17, v56
    v_lshlrev_b32 v78, 16, v57
    v_and_b32 v79, s17, v57
    v_lshlrev_b32 v80, 16, v58
    v_and_b32 v81, s17, v58
    v_lshlrev_b32 v82, 16, v59
    v_and_b32 v83, s17, v59
    v_mul_f32 v76, v76, v68
    v_mul_f32 v77, v77, v69
    v_mul_f32 v78, v78, v70
    v_mul_f32 v79, v79, v71
    v_mul_f32 v80, v80, v72
    v_mul_f32 v81, v81, v73
    v_mul_f32 v82, v82, v74
    v_mul_f32 v83, v83, v75
    v_cvt_pk_bf16_f32 v84, v76, v77
    v_cvt_pk_bf16_f32 v85, v78, v79
    v_cvt_pk_bf16_f32 v86, v80, v81
    v_cvt_pk_bf16_f32 v87, v82, v83
    v_lshlrev_b32 v76, 16, v84
    v_and_b32 v77, s17, v84
    v_lshlrev_b32 v78, 16, v85
    v_and_b32 v79, s17, v85
    v_lshlrev_b32 v80, 16, v86
    v_and_b32 v81, s17, v86
    v_lshlrev_b32 v82, 16, v87
    v_and_b32 v83, s17, v87
    v_add_f32 v76, v76, v77
    v_add_f32 v78, v78, v79
    v_add_f32 v80, v80, v81
    v_add_f32 v82, v82, v83
    v_add_f32 v76, v76, v78
    v_add_f32 v80, v80, v82
    v_add_f32 v88, v76, v80
    v_lshlrev_b32 v76, 16, v60
    v_and_b32 v77, s17, v60
    v_lshlrev_b32 v78, 16, v61
    v_and_b32 v79, s17, v61
    v_lshlrev_b32 v80, 16, v62
    v_and_b32 v81, s17, v62
    v_lshlrev_b32 v82, 16, v63
    v_and_b32 v83, s17, v63
    v_mul_f32 v76, v76, v68
    v_mul_f32 v77, v77, v69
    v_mul_f32 v78, v78, v70
    v_mul_f32 v79, v79, v71
    v_mul_f32 v80, v80, v72
    v_mul_f32 v81, v81, v73
    v_mul_f32 v82, v82, v74
    v_mul_f32 v83, v83, v75
    v_cvt_pk_bf16_f32 v84, v76, v77
    v_cvt_pk_bf16_f32 v85, v78, v79
    v_cvt_pk_bf16_f32 v86, v80, v81
    v_cvt_pk_bf16_f32 v87, v82, v83
    v_lshlrev_b32 v76, 16, v84
    v_and_b32 v77, s17, v84
    v_lshlrev_b32 v78, 16, v85
    v_and_b32 v79, s17, v85
    v_lshlrev_b32 v80, 16, v86
    v_and_b32 v81, s17, v86
    v_lshlrev_b32 v82, 16, v87
    v_and_b32 v83, s17, v87
    v_add_f32 v76, v76, v77
    v_add_f32 v78, v78, v79
    v_add_f32 v80, v80, v81
    v_add_f32 v82, v82, v83
    v_add_f32 v76, v76, v78
    v_add_f32 v80, v80, v82
    v_add_f32 v89, v76, v80
    s_nop 1
    v_permlane32_swap_b32 v88, v89
    s_nop 1
    v_add_f32 v88, v88, v89
    v_mov_b32 v89, v88
    s_nop 1
    v_permlane16_swap_b32 v88, v89
    s_nop 1
    v_add_f32 v88, v88, v89
    s_nop 1
    v_add_f32_dpp v88, v88, v88 row_ror:8 row_mask:0xf bank_mask:0xf
    s_nop 1
    v_add_f32_dpp v88, v88, v88 row_ror:4 row_mask:0xf bank_mask:0xf
    s_nop 1
    v_add_f32_dpp v88, v88, v88 row_ror:2 row_mask:0xf bank_mask:0xf
    s_nop 1
    v_add_f32_dpp v88, v88, v88 row_ror:1 row_mask:0xf bank_mask:0xf
    v_cvt_pk_bf16_f32 v88, v88, v88
    s_mov_b32 s16, 1069066811
    v_and_b32 v88, s17, v88
    v_mul_f32 v88, s16, v88
    v_sub_f32 v88, 0, v88
    v_exp_f32 v88, v88
    s_nop 0
    v_add_f32 v88, 1.0, v88
    v_rcp_f32 v88, v88
    s_nop 0
    v_cvt_pk_bf16_f32 v88, v88, v88
    v_and_b32 v151, s17, v88
    v_sub_f32 v88, 1.0, v151
    v_cvt_pk_bf16_f32 v88, v88, v88
    v_and_b32 v152, s17, v88
    ds_read_b32 v7, v4 offset:0
    s_waitcnt lgkmcnt(0)
    v_readfirstlane_b32 s10, v7
    s_cmp_lg_u32 s10, 0
    s_cbranch_scc1 L_B_dry4
    s_mov_b32 s14, 0
    s_mov_b64 s[58:59], 0
    s_mov_b64 exec, 0
    s_branch L_S_qk
L_B_dry4:
    s_mov_b64 s[58:59], -1
    s_mov_b64 exec, -1
    s_mov_b32 s16, 1069066811
    s_mov_b32 s17, 0xffff0000
    s_and_b32 s13, s5, 3
    s_lshr_b32 s23, s2, 2
    s_mul_i32 s28, s23, 43
    s_lshr_b32 s29, s28, 3
    s_add_u32 s28, s28, 43
    s_lshr_b32 s28, s28, 3
    s_sub_u32 s28, s28, s29
    s_lshl_b32 s15, s29, 12
    s_lshl_b32 s18, s13, 8
    s_add_u32 s15, s15, s18
    s_lshl_b32 s14, s23, 16
    s_add_u32 s14, s14, s18
    s_lshl_b32 s19, s4, 13
    s_add_u32 s19, s19, 786432
    s_lshl_b32 s20, s23, 6
    s_lshl_b32 s18, s13, 12
    s_add_u32 s20, s20, s18
    s_add_u32 s20, s20, 1048576
    s_lshl_b32 s22, s23, 12
    s_add_u32 s22, s22, 1048576
    s_and_b32 s21, s23, 3
    s_bfe_u32 s24, s23, 0x10005
    s_lshl_b32 s24, s24, 10
    s_lshl_b32 s21, s21, 8
    s_add_u32 s24, s24, s21
    s_bfe_u32 s21, s23, 0x20002
    s_lshl_b32 s21, s21, 6
    s_add_u32 s24, s24, s21
    s_bfe_u32 s21, s23, 0x10004
    s_lshl_b32 s21, s21, 3
    s_add_u32 s24, s24, s21
    s_xor_b32 s21, s4, s2
    s_and_b32 s21, s21, 3
    s_lshl_b32 s30, s13, 7
    s_add_u32 s30, s30, 1376256
    s_mov_b64 s[60:61], s[48:49]
    s_mov_b32 s62, 1409024
    s_mov_b32 s63, 0x20000
    s_mov_b64 s[64:65], s[40:41]
    s_mov_b32 s66, 4194304
    s_mov_b32 s67, 0x20000
    v_lshlrev_b32 v5, 4, v3
    v_lshl_add_u32 v6, v2, 10, v5
    v_lshl_add_u32 v5, v2, 14, v5
    v_bfe_u32 v14, v0, 2, 3
    v_add_u32 v15, s29, v14
    v_lshrrev_b32 v1, 4, v15
    v_lshlrev_b32 v1, 13, v1
    v_and_b32 v15, 15, v15
    v_lshl_add_u32 v1, v15, 6, v1
    v_and_b32 v15, 3, v0
    v_lshl_add_u32 v1, v15, 4, v1
    v_lshrrev_b32 v7, 5, v0
    v_lshl_add_u32 v1, v7, 10, v1
    v_and_b32 v15, 1, v0
    v_lshlrev_b32 v15, 6, v15
    v_lshl_add_u32 v15, v7, 4, v15
    v_lshl_add_u32 v15, v14, 1, v15
    s_mov_b32 s97, 524288
    s_mov_b32 s98, 528384
    v_cmp_gt_u32 s[8:9], s28, v14
    v_mov_b32 v120, 0
    v_mov_b32 v121, 0
    v_mov_b32 v122, 0
    v_mov_b32 v123, 0
    v_mov_b32 v124, 0
    v_mov_b32 v125, 0
    v_mov_b32 v126, 0
    v_mov_b32 v127, 0
    v_mov_b32 v128, 0
    v_mov_b32 v129, 0
    v_mov_b32 v130, 0
    v_mov_b32 v131, 0
    v_mov_b32 v132, 0
    v_mov_b32 v133, 0
    v_mov_b32 v134, 0
    v_mov_b32 v135, 0
    s_setprio 3
    s_mov_b32 s11, 400000
Lp_32:
    ds_read_b32 v7, v4 offset:4
    s_sub_u32 s11, s11, 1
    s_cbranch_scc1 Lpd_33
    s_waitcnt lgkmcnt(0)
    v_readfirstlane_b32 s10, v7
    s_cmp_lt_u32 s10, 4
    s_cbranch_scc1 Lp_32
Lpd_33:
    s_mov_b64 exec, s[8:9]
    buffer_load_dwordx4 v[120:123], v1, s[68:71], s97 offen offset:0 sc1
    buffer_load_dwordx4 v[124:127], v1, s[68:71], s97 offen offset:2048 sc1
    buffer_load_dwordx4 v[128:131], v1, s[68:71], s98 offen offset:0 sc1
    buffer_load_dwordx4 v[132:135], v1, s[68:71], s98 offen offset:2048 sc1
    s_mov_b64 exec, 0xff
    buffer_load_dwordx4 v[136:139], v8, s[68:71], s19 offen offset:512 sc1
    s_mov_b64 exec, -1
    s_add_u32 s18, s15, 0
    buffer_load_dwordx4 v[32:35], v6, s[60:63], s18 offen nt
    s_add_u32 s18, s15, 4096
    buffer_load_dwordx4 v[36:39], v6, s[60:63], s18 offen nt
    s_add_u32 s18, s15, 8192
    buffer_load_dwordx4 v[40:43], v6, s[60:63], s18 offen nt
    s_add_u32 s18, s15, 12288
    buffer_load_dwordx4 v[44:47], v6, s[60:63], s18 offen nt
    s_add_u32 s18, s15, 16384
    buffer_load_dwordx4 v[48:51], v6, s[60:63], s18 offen nt
    s_add_u32 s18, s15, 20480
    buffer_load_dwordx4 v[52:55], v6, s[60:63], s18 offen nt
    s_add_u32 s18, s14, 0
    buffer_load_dwordx4 v[56:59], v5, s[64:67], s18 offen offset:0 nt
    buffer_load_dwordx4 v[60:63], v5, s[64:67], s18 offen offset:1024 nt
    buffer_load_dwordx4 v[64:67], v5, s[64:67], s18 offen offset:2048 nt
    buffer_load_dwordx4 v[68:71], v5, s[64:67], s18 offen offset:3072 nt
    s_add_u32 s18, s14, 4096
    buffer_load_dwordx4 v[72:75], v5, s[64:67], s18 offen offset:0 nt
    buffer_load_dwordx4 v[76:79], v5, s[64:67], s18 offen offset:1024 nt
    buffer_load_dwordx4 v[80:83], v5, s[64:67], s18 offen offset:2048 nt
    buffer_load_dwordx4 v[84:87], v5, s[64:67], s18 offen offset:3072 nt
    s_add_u32 s18, s14, 8192
    buffer_load_dwordx4 v[88:91], v5, s[64:67], s18 offen offset:0 nt
    buffer_load_dwordx4 v[92:95], v5, s[64:67], s18 offen offset:1024 nt
    buffer_load_dwordx4 v[96:99], v5, s[64:67], s18 offen offset:2048 nt
    buffer_load_dwordx4 v[100:103], v5, s[64:67], s18 offen offset:3072 nt
    s_add_u32 s18, s14, 12288
    buffer_load_dwordx4 v[104:107], v5, s[64:67], s18 offen offset:0 nt
    buffer_load_dwordx4 v[108:111], v5, s[64:67], s18 offen offset:1024 nt
    buffer_load_dwordx4 v[112:115], v5, s[64:67], s18 offen offset:2048 nt
    buffer_load_dwordx4 v[116:119], v5, s[64:67], s18 offen offset:3072 nt
    s_waitcnt vmcnt(23)
    s_mov_b64 exec, s[8:9]
L_B_h:
    s_mov_b32 s11, 40000
Lgc_35:
    v_perm_b32 v153, v121, v120, v149
    v_perm_b32 v154, v123, v122, v150
    v_perm_b32 v155, v125, v124, v149
    v_perm_b32 v156, v127, v126, v150
    v_perm_b32 v157, v129, v128, v149
    v_perm_b32 v158, v131, v130, v150
    v_perm_b32 v159, v133, v132, v149
    v_perm_b32 v160, v135, v134, v150
    v_or_b32 v153, v153, v154
    v_xor_b32 v153, s7, v153
    v_or_b32 v155, v155, v156
    v_xor_b32 v155, s7, v155
    v_or_b32 v157, v157, v158
    v_xor_b32 v157, s7, v157
    v_or_b32 v159, v159, v160
    v_xor_b32 v159, s7, v159
    v_or_b32 v153, v153, v155
    v_or_b32 v153, v153, v157
    v_or_b32 v153, v153, v159
    v_cmp_ne_u32 vcc, 0, v153
    s_and_b64 exec, exec, vcc
    s_cbranch_scc1 Lg_34
Lg_34d:
    s_mov_b64 exec, s[58:59]
    v_and_b32 v120, 0xffffff00, v120
    v_and_b32 v121, 0xffffff00, v121
    v_and_b32 v122, 0xffffff00, v122
    v_and_b32 v123, 0xffffff00, v123
    v_and_b32 v124, 0xffffff00, v124
    v_and_b32 v125, 0xffffff00, v125
    v_and_b32 v126, 0xffffff00, v126
    v_and_b32 v127, 0xffffff00, v127
    v_and_b32 v128, 0xffffff00, v128
    v_and_b32 v129, 0xffffff00, v129
    v_and_b32 v130, 0xffffff00, v130
    v_and_b32 v131, 0xffffff00, v131
    v_and_b32 v132, 0xffffff00, v132
    v_and_b32 v133, 0xffffff00, v133
    v_and_b32 v134, 0xffffff00, v134
    v_and_b32 v135, 0xffffff00, v135
    v_add_f32 v120, v120, v124
    v_add_f32 v121, v121, v125
    v_add_f32 v122, v122, v126
    v_add_f32 v123, v123, v127
    v_add_f32 v120, v120, v128
    v_add_f32 v121, v121, v129
    v_add_f32 v122, v122, v130
    v_add_f32 v123, v123, v131
    v_add_f32 v120, v120, v132
    v_add_f32 v121, v121, v133
    v_add_f32 v122, v122, v134
    v_add_f32 v123, v123, v135
    s_nop 0
    v_permlane32_swap_b32 v120, v121
    v_permlane32_swap_b32 v122, v123
    s_nop 1
    v_add_f32 v120, v120, v121
    v_add_f32 v122, v122, v123
    v_cvt_pk_bf16_f32 v120, v120, v122
    v_lshlrev_b32 v124, 16, v120
    v_and_b32 v125, s17, v120
    s_nop 1
    v_mul_f32_dpp v126, v124, v124 quad_perm:[2,3,0,1] row_mask:0xf bank_mask:0xf
    v_mul_f32_dpp v127, v125, v125 quad_perm:[2,3,0,1] row_mask:0xf bank_mask:0xf
    v_cvt_pk_bf16_f32 v120, v126, v127
    ds_write_b16 v15, v120 offset:320
    ds_write_b16_d16_hi v15, v120 offset:352
    ds_read_b128 v[132:135], v10 offset:320
    v_mov_b32 v14, 1
    s_waitcnt lgkmcnt(0)
    v_lshlrev_b32 v15, 9, v0
    s_waitcnt vmcnt(22)
    s_and_b64 exec, s[58:59], 0xff
    s_mov_b32 s11, 40000
Lgc_37:
    v_perm_b32 v153, v137, v136, v149
    v_perm_b32 v154, v139, v138, v150
    v_or_b32 v153, v153, v154
    v_xor_b32 v153, s7, v153
    v_cmp_ne_u32 vcc, 0, v153
    s_and_b64 exec, exec, vcc
    s_cbranch_scc1 Lg_36
Lg_36d:
    s_mov_b64 exec, s[58:59]
    s_cbranch_execz Lm_38
    buffer_load_dwordx4 v[120:123], v9, s[68:71], s19 offen sc1
    buffer_load_dwordx4 v[124:127], v9, s[68:71], s19 offen offset:2048 sc1
Lm_38:
    v_and_b32 v137, 0xffffff00, v137
    v_and_b32 v136, s17, v136
    s_nop 1
    v_max_f32_dpp v153, v136, v136 quad_perm:[1,0,3,2] row_mask:0xf bank_mask:0xf
    s_nop 1
    v_max_f32_dpp v153, v153, v153 quad_perm:[2,3,0,1] row_mask:0xf bank_mask:0xf
    v_sub_f32 v153, v136, v153
    v_mul_f32 v153, s16, v153
    v_exp_f32 v153, v153
    s_nop 0
    v_mul_f32 v154, v153, v137
    s_nop 1
    v_add_f32_dpp v154, v154, v154 quad_perm:[1,0,3,2] row_mask:0xf bank_mask:0xf
    s_nop 1
    v_add_f32_dpp v154, v154, v154 quad_perm:[2,3,0,1] row_mask:0xf bank_mask:0xf
    v_rcp_f32 v154, v154
    s_nop 0
    v_mul_f32 v153, v153, v154
    ds_bpermute_b32 v166, v165, v153
    ds_bpermute_b32 v167, v165, v153 offset:8
    v_perm_b32 v24, v132, v132, v16
    v_perm_b32 v25, v132, v132, v18
    v_perm_b32 v26, v132, v132, v20
    v_perm_b32 v27, v132, v132, v22
    v_perm_b32 v28, v132, v132, v17
    v_perm_b32 v29, v132, v132, v19
    v_perm_b32 v30, v132, v132, v21
    v_perm_b32 v31, v132, v132, v23
    s_waitcnt vmcnt(23)
    v_mfma_f32_16x16x32_bf16 v[140:143], v[24:27], v[32:35], 0
    v_perm_b32 v24, v133, v133, v16
    v_perm_b32 v25, v133, v133, v18
    v_perm_b32 v26, v133, v133, v20
    v_perm_b32 v27, v133, v133, v22
    s_waitcnt vmcnt(22)
    v_mfma_f32_16x16x32_bf16 v[140:143], v[28:31], v[36:39], v[140:143]
    v_perm_b32 v28, v133, v133, v17
    v_perm_b32 v29, v133, v133, v19
    v_perm_b32 v30, v133, v133, v21
    v_perm_b32 v31, v133, v133, v23
    s_waitcnt vmcnt(21)
    v_mfma_f32_16x16x32_bf16 v[140:143], v[24:27], v[40:43], v[140:143]
    v_perm_b32 v24, v134, v134, v16
    v_perm_b32 v25, v134, v134, v18
    v_perm_b32 v26, v134, v134, v20
    v_perm_b32 v27, v134, v134, v22
    s_waitcnt vmcnt(20)
    v_mfma_f32_16x16x32_bf16 v[140:143], v[28:31], v[44:47], v[140:143]
    v_perm_b32 v28, v134, v134, v17
    v_perm_b32 v29, v134, v134, v19
    v_perm_b32 v30, v134, v134, v21
    v_perm_b32 v31, v134, v134, v23
    s_waitcnt vmcnt(19)
    v_mfma_f32_16x16x32_bf16 v[140:143], v[24:27], v[48:51], v[140:143]
    s_waitcnt vmcnt(18)
    v_mfma_f32_16x16x32_bf16 v[140:143], v[28:31], v[52:55], v[140:143]
    s_mov_b32 s11, 40000
    s_waitcnt lgkmcnt(0)
    s_nop 5
    v_mul_f32 v140, v152, v140
    v_mul_f32 v141, v152, v141
    v_mul_f32 v142, v152, v142
    v_mul_f32 v143, v152, v143
    s_branch L_B_oc
L_B_ol:
    buffer_load_dwordx4 v[120:123], v9, s[68:71], s19 offen sc1
    buffer_load_dwordx4 v[124:127], v9, s[68:71], s19 offen offset:2048 sc1
L_B_oc:
    s_waitcnt vmcnt(0)
    v_perm_b32 v153, v121, v120, v149
    v_perm_b32 v154, v123, v122, v150
    v_perm_b32 v155, v125, v124, v149
    v_perm_b32 v156, v127, v126, v150
    v_or_b32 v153, v153, v154
    v_xor_b32 v153, s7, v153
    v_or_b32 v155, v155, v156
    v_xor_b32 v155, s7, v155
    v_or_b32 v153, v153, v155
    v_cmp_ne_u32 vcc, 0, v153
    v_and_b32 v120, 0xffffff00, v120
    v_and_b32 v121, 0xffffff00, v121
    v_and_b32 v122, 0xffffff00, v122
    v_and_b32 v123, 0xffffff00, v123
    v_and_b32 v124, 0xffffff00, v124
    v_and_b32 v125, 0xffffff00, v125
    v_and_b32 v126, 0xffffff00, v126
    v_and_b32 v127, 0xffffff00, v127
    v_mul_f32 v32, v166, v120
    v_mul_f32 v33, v166, v121
    v_mul_f32 v34, v166, v122
    v_mul_f32 v35, v166, v123
    v_fma_f32 v32, v167, v124, v32
    v_fma_f32 v33, v167, v125, v33
    v_fma_f32 v34, v167, v126, v34
    v_fma_f32 v35, v167, v127, v35
    s_sub_u32 s11, s11, 1
    s_cbranch_scc1 L_B_od
    s_and_b64 exec, exec, vcc
    s_cbranch_scc1 L_B_ol
L_B_od:
    s_mov_b64 exec, s[58:59]
    v_add_f32_dpp v36, v32, v32 row_ror:12 row_mask:0xf bank_mask:0x5
    v_add_f32_dpp v37, v33, v33 row_ror:12 row_mask:0xf bank_mask:0x5
    v_add_f32_dpp v38, v34, v34 row_ror:12 row_mask:0xf bank_mask:0x5
    v_add_f32_dpp v39, v35, v35 row_ror:12 row_mask:0xf bank_mask:0x5
    v_add_f32_dpp v36, v32, v32 row_ror:4 row_mask:0xf bank_mask:0xa
    v_add_f32_dpp v37, v33, v33 row_ror:4 row_mask:0xf bank_mask:0xa
    v_add_f32_dpp v38, v34, v34 row_ror:4 row_mask:0xf bank_mask:0xa
    v_add_f32_dpp v39, v35, v35 row_ror:4 row_mask:0xf bank_mask:0xa
    v_cvt_pk_bf16_f32 v32, v36, v37
    v_cvt_pk_bf16_f32 v33, v38, v39
    s_cbranch_execz Lm_39
    s_mov_b64 exec, 0xffff
    buffer_atomic_add v14, v15, s[68:71], s30 offen
    s_mov_b64 exec, -1
Lm_39:
    s_cmp_lg_u32 s21, 0
    v_mov_b32_dpp v155, v32 quad_perm:[0,0,0,0] row_mask:0xf bank_mask:0xf
    v_mov_b32_dpp v156, v33 quad_perm:[0,0,0,0] row_mask:0xf bank_mask:0xf
    v_mov_b32_dpp v157, v32 quad_perm:[1,1,1,1] row_mask:0xf bank_mask:0xf
    v_mov_b32_dpp v158, v33 quad_perm:[1,1,1,1] row_mask:0xf bank_mask:0xf
    v_mov_b32_dpp v159, v32 quad_perm:[2,2,2,2] row_mask:0xf bank_mask:0xf
    v_mov_b32_dpp v160, v33 quad_perm:[2,2,2,2] row_mask:0xf bank_mask:0xf
    v_mov_b32_dpp v161, v32 quad_perm:[3,3,3,3] row_mask:0xf bank_mask:0xf
    v_mov_b32_dpp v162, v33 quad_perm:[3,3,3,3] row_mask:0xf bank_mask:0xf
    v_perm_b32 v24, v155, v155, v16
    v_perm_b32 v25, v155, v155, v18
    v_perm_b32 v26, v155, v155, v20
    v_perm_b32 v27, v155, v155, v22
    v_perm_b32 v28, v155, v155, v17
    v_perm_b32 v29, v155, v155, v19
    v_perm_b32 v30, v155, v155, v21
    v_perm_b32 v31, v155, v155, v23
    v_mfma_f32_16x16x32_bf16 v[136:139], v[24:27], v[56:59], 0
    v_perm_b32 v24, v156, v156, v16
    v_perm_b32 v25, v156, v156, v18
    v_perm_b32 v26, v156, v156, v20
    v_perm_b32 v27, v156, v156, v22
    v_mfma_f32_16x16x32_bf16 v[136:139], v[28:31], v[60:63], v[136:139]
    v_perm_b32 v28, v156, v156, v17
    v_perm_b32 v29, v156, v156, v19
    v_perm_b32 v30, v156, v156, v21
    v_perm_b32 v31, v156, v156, v23
    v_mfma_f32_16x16x32_bf16 v[136:139], v[24:27], v[64:67], v[136:139]
    v_perm_b32 v24, v157, v157, v16
    v_perm_b32 v25, v157, v157, v18
    v_perm_b32 v26, v157, v157, v20
    v_perm_b32 v27, v157, v157, v22
    v_mfma_f32_16x16x32_bf16 v[136:139], v[28:31], v[68:71], v[136:139]
    v_perm_b32 v28, v157, v157, v17
    v_perm_b32 v29, v157, v157, v19
    v_perm_b32 v30, v157, v157, v21
    v_perm_b32 v31, v157, v157, v23
    v_mfma_f32_16x16x32_bf16 v[136:139], v[24:27], v[72:75], v[136:139]
    v_perm_b32 v24, v158, v158, v16
    v_perm_b32 v25, v158, v158, v18
    v_perm_b32 v26, v158, v158, v20
    v_perm_b32 v27, v158, v158, v22
    v_mfma_f32_16x16x32_bf16 v[136:139], v[28:31], v[76:79], v[136:139]
    v_perm_b32 v28, v158, v158, v17
    v_perm_b32 v29, v158, v158, v19
    v_perm_b32 v30, v158, v158, v21
    v_perm_b32 v31, v158, v158, v23
    v_mfma_f32_16x16x32_bf16 v[136:139], v[24:27], v[80:83], v[136:139]
    v_perm_b32 v24, v159, v159, v16
    v_perm_b32 v25, v159, v159, v18
    v_perm_b32 v26, v159, v159, v20
    v_perm_b32 v27, v159, v159, v22
    v_mfma_f32_16x16x32_bf16 v[136:139], v[28:31], v[84:87], v[136:139]
    v_perm_b32 v28, v159, v159, v17
    v_perm_b32 v29, v159, v159, v19
    v_perm_b32 v30, v159, v159, v21
    v_perm_b32 v31, v159, v159, v23
    v_mfma_f32_16x16x32_bf16 v[136:139], v[24:27], v[88:91], v[136:139]
    v_perm_b32 v24, v160, v160, v16
    v_perm_b32 v25, v160, v160, v18
    v_perm_b32 v26, v160, v160, v20
    v_perm_b32 v27, v160, v160, v22
    v_mfma_f32_16x16x32_bf16 v[136:139], v[28:31], v[92:95], v[136:139]
    v_perm_b32 v28, v160, v160, v17
    v_perm_b32 v29, v160, v160, v19
    v_perm_b32 v30, v160, v160, v21
    v_perm_b32 v31, v160, v160, v23
    v_mfma_f32_16x16x32_bf16 v[136:139], v[24:27], v[96:99], v[136:139]
    v_perm_b32 v24, v161, v161, v16
    v_perm_b32 v25, v161, v161, v18
    v_perm_b32 v26, v161, v161, v20
    v_perm_b32 v27, v161, v161, v22
    v_mfma_f32_16x16x32_bf16 v[136:139], v[28:31], v[100:103], v[136:139]
    v_perm_b32 v28, v161, v161, v17
    v_perm_b32 v29, v161, v161, v19
    v_perm_b32 v30, v161, v161, v21
    v_perm_b32 v31, v161, v161, v23
    v_mfma_f32_16x16x32_bf16 v[136:139], v[24:27], v[104:107], v[136:139]
    v_perm_b32 v24, v162, v162, v16
    v_perm_b32 v25, v162, v162, v18
    v_perm_b32 v26, v162, v162, v20
    v_perm_b32 v27, v162, v162, v22
    v_mfma_f32_16x16x32_bf16 v[136:139], v[28:31], v[108:111], v[136:139]
    v_perm_b32 v28, v162, v162, v17
    v_perm_b32 v29, v162, v162, v19
    v_perm_b32 v30, v162, v162, v21
    v_perm_b32 v31, v162, v162, v23
    v_mfma_f32_16x16x32_bf16 v[136:139], v[24:27], v[112:115], v[136:139]
    s_nop 0
    v_mfma_f32_16x16x32_bf16 v[136:139], v[28:31], v[116:119], v[136:139]
    s_mov_b32 s11, 300
    s_nop 6
    v_fma_f32 v136, v151, v136, v140
    v_fma_f32 v137, v151, v137, v141
    v_fma_f32 v138, v151, v138, v142
    v_fma_f32 v139, v151, v139, v143
    v_bfi_b32 v136, v148, v144, v136
    v_bfi_b32 v137, v148, v145, v137
    v_bfi_b32 v138, v148, v146, v138
    v_bfi_b32 v139, v148, v147, v139
    s_cbranch_execz L_B_fc
    buffer_store_dwordx4 v[136:139], v11, s[68:71], s20 offen sc1
    s_cbranch_scc1 L_B_end
L_B_hl:
    s_load_dword s10, s[100:101], 0 glc
    s_sub_u32 s11, s11, 1
    s_cbranch_scc1 L_B_hd
    s_waitcnt lgkmcnt(0)
    s_sub_u32 s10, s10, s99
    s_cmp_lt_u32 s10, 64
    s_cbranch_scc1 L_B_hl
L_B_hd:
    s_mov_b32 s11, 40000
L_B_fl:
    buffer_load_dwordx4 v[32:35], v12, s[68:71], s22 offen offset:0 sc1
    buffer_load_dwordx4 v[36:39], v12, s[68:71], s22 offen offset:1024 sc1
    buffer_load_dwordx4 v[40:43], v12, s[68:71], s22 offen offset:2048 sc1
    buffer_load_dwordx4 v[44:47], v12, s[68:71], s22 offen offset:3072 sc1
    s_waitcnt vmcnt(0)
L_B_fc:
    v_perm_b32 v153, v33, v32, v149
    v_perm_b32 v154, v35, v34, v150
    v_perm_b32 v155, v37, v36, v149
    v_perm_b32 v156, v39, v38, v150
    v_perm_b32 v157, v41, v40, v149
    v_perm_b32 v158, v43, v42, v150
    v_perm_b32 v159, v45, v44, v149
    v_perm_b32 v160, v47, v46, v150
    v_or_b32 v153, v153, v154
    v_xor_b32 v153, s7, v153
    v_or_b32 v155, v155, v156
    v_xor_b32 v155, s7, v155
    v_or_b32 v157, v157, v158
    v_xor_b32 v157, s7, v157
    v_or_b32 v159, v159, v160
    v_xor_b32 v159, s7, v159
    v_or_b32 v153, v153, v155
    v_or_b32 v153, v153, v157
    v_or_b32 v153, v153, v159
    v_cmp_ne_u32 vcc, 0, v153
    v_and_b32 v32, 0xffffff00, v32
    v_and_b32 v33, 0xffffff00, v33
    v_and_b32 v34, 0xffffff00, v34
    v_and_b32 v35, 0xffffff00, v35
    v_and_b32 v36, 0xffffff00, v36
    v_and_b32 v37, 0xffffff00, v37
    v_and_b32 v38, 0xffffff00, v38
    v_and_b32 v39, 0xffffff00, v39
    v_and_b32 v40, 0xffffff00, v40
    v_and_b32 v41, 0xffffff00, v41
    v_and_b32 v42, 0xffffff00, v42
    v_and_b32 v43, 0xffffff00, v43
    v_and_b32 v44, 0xffffff00, v44
    v_and_b32 v45, 0xffffff00, v45
    v_and_b32 v46, 0xffffff00, v46
    v_and_b32 v47, 0xffffff00, v47
    v_add_f32 v48, v32, v36
    v_add_f32 v49, v33, v37
    v_add_f32 v50, v34, v38
    v_add_f32 v51, v35, v39
    v_add_f32 v52, v40, v44
    v_add_f32 v53, v41, v45
    v_add_f32 v54, v42, v46
    v_add_f32 v55, v43, v47
    v_add_f32 v48, v48, v52
    v_add_f32 v49, v49, v53
    v_add_f32 v50, v50, v54
    v_add_f32 v51, v51, v55
    s_sub_u32 s11, s11, 1
    s_cbranch_scc1 L_B_fd
    s_and_b64 exec, exec, vcc
    s_cbranch_scc1 L_B_fl
L_B_fd:
    s_mov_b64 exec, s[58:59]
    v_permlane32_swap_b32 v48, v49
    v_permlane32_swap_b32 v50, v51
    s_nop 1
    v_add_f32 v48, v48, v49
    v_add_f32 v50, v50, v51
    s_nop 1
    v_permlane16_swap_b32 v48, v50
    s_nop 1
    v_add_f32 v48, v48, v50
    s_nop 1
    v_add_f32_dpp v48, v48, v48 row_ror:8 row_mask:0xf bank_mask:0xf
    s_nop 1
    v_add_f32_dpp v48, v48, v48 row_ror:4 row_mask:0xf bank_mask:0xf
    v_cvt_pk_bf16_f32 v48, v48, v48
    s_cbranch_execz L_B_dry3
    s_mov_b32 exec_lo, 0x000f000f
    s_mov_b32 exec_hi, 0x000f000f
    buffer_store_short v48, v13, s[72:75], s24 offen sc1
    s_cmp_lg_u32 s2, 0
    s_cbranch_scc1 L_B_st
    s_add_u32 s6, s6, 1
    v_mov_b32 v5, s6
    s_mov_b64 exec, 1
    buffer_store_dword v5, v4, s[68:71], 0 offen sc1
L_B_st:
L_B_end:
    s_endpgm
Lg_1:
    s_sub_u32 s11, s11, 1
    s_cbranch_scc1 Lg_1d
    buffer_load_dwordx4 v[40:43], v36, s[68:71], s14 offen offset:0 sc1
    buffer_load_dwordx4 v[44:47], v36, s[68:71], s14 offen offset:2048 sc1
    buffer_load_dwordx4 v[48:51], v36, s[68:71], s16 offen offset:0 sc1
    buffer_load_dwordx4 v[52:55], v36, s[68:71], s16 offen offset:2048 sc1
    s_waitcnt vmcnt(0)
    s_branch Lgc_2
Lg_34:
    s_sub_u32 s11, s11, 1
    s_cbranch_scc1 Lg_34d
    buffer_load_dwordx4 v[120:123], v1, s[68:71], s97 offen offset:0 sc1
    buffer_load_dwordx4 v[124:127], v1, s[68:71], s97 offen offset:2048 sc1
    buffer_load_dwordx4 v[128:131], v1, s[68:71], s98 offen offset:0 sc1
    buffer_load_dwordx4 v[132:135], v1, s[68:71], s98 offen offset:2048 sc1
    s_waitcnt vmcnt(0)
    s_branch Lgc_35
Lg_36:
    s_sub_u32 s11, s11, 1
    s_cbranch_scc1 Lg_36d
    buffer_load_dwordx4 v[136:139], v8, s[68:71], s19 offen offset:512 sc1
    s_waitcnt vmcnt(0)
    s_branch Lgc_37
L_exit:
    s_endpgm
.section .rodata,"a"
.p2align 6
.amdhsa_kernel gated_mix__sliding_block_cached__glu_gated_bilinear__decode_kernel
  .amdhsa_next_free_vgpr 168
  .amdhsa_next_free_sgpr 102
  .amdhsa_accum_offset 168
  .amdhsa_group_segment_fixed_size 0
  .amdhsa_kernarg_size 104
  .amdhsa_user_sgpr_count 2
  .amdhsa_user_sgpr_kernarg_segment_ptr 1
  .amdhsa_system_sgpr_workgroup_id_x 1
  .amdhsa_float_denorm_mode_32 3
.end_amdhsa_kernel
```
